```python
import torch

def _softmax(x, axis=-1):
    return torch.softmax(x, dim=axis)
def _gelu(x):
    return torch.nn.functional.gelu(x, approximate="tanh")
def _silu(x):
    return torch.nn.functional.silu(x)
def _sigmoid(x):
    return torch.sigmoid(x)
def _layernorm(x, axis=-1, eps=1e-5):
    m = x.mean(dim=axis, keepdim=True)
    v = x.var(dim=axis, keepdim=True, unbiased=False)
    return (x - m) / torch.sqrt(v + eps)
def _scatter_add(tgt, idx, src, axis=0):
    return tgt.clone().index_add_(axis, idx, src)
def _segment_sum(src, seg, n):
    out = torch.zeros((n,) + src.shape[1:], dtype=src.dtype)
    return out.index_add_(0, seg, src)
def _pad(x, pw):
    flat = tuple(v for pair in reversed(pw) for v in pair)
    return torch.nn.functional.pad(x, flat)

kernel_name = 'interleave_layers__ssm_conv_h3__dense_activation_silu__prompt'

def setup_inputs():

    _w = (lambda a: (lambda t: t.to(torch.bfloat16) if t.is_floating_point() else t)(torch.as_tensor(a)))
    def _A_setup():
        B, S, D = 1, 2048, 448
        ks = 4
        return {
            "q": _w((lambda *s: torch.randn(*s, dtype=torch.bfloat16) * 0.05)(B, S, D)),
            "k": _w((lambda *s: torch.randn(*s, dtype=torch.bfloat16) * 0.2)(B, S, D)),
            "v": _w((lambda *s: torch.randn(*s, dtype=torch.bfloat16) * 0.2)(B, S, D)),
            "shift_k": _w((lambda *s: torch.randn(*s, dtype=torch.bfloat16) * 0.2)(D, ks) * 0.5),
            "ssm_k": _w((lambda *s: torch.randn(*s, dtype=torch.bfloat16) * 0.4)(D, S) * (1.0 / S ** 0.5)),
            "ssm_D": _w((lambda *s: torch.randn(*s, dtype=torch.bfloat16) * 0.2)(D)),
        }
    _A_in = _A_setup()

    def _B_setup():
        B, S, D, F = 1, 2048, 448, 1792
        return {
            "x": _w((lambda *s: torch.randn(*s, dtype=torch.bfloat16) * 0.05)(B, S, D)),
            "w1": _w((lambda *s: torch.randn(*s, dtype=torch.bfloat16) * 0.4)(D, F) * (D ** -0.5)),
            "w2": _w((lambda *s: torch.randn(*s, dtype=torch.bfloat16) * 0.1)(F, D) * (F ** -0.5)),
        }
    _B_in = _B_setup()

    return {
        "A_q": _A_in["q"],
        "A_k": _A_in["k"],
        "A_v": _A_in["v"],
        "A_shift_k": _A_in["shift_k"],
        "A_ssm_k": _A_in["ssm_k"],
        "A_ssm_D": _A_in["ssm_D"],
        "B_x": _B_in["x"],
        "B_w1": _B_in["w1"],
        "B_w2": _B_in["w2"],
    }

def reference(A_q, A_k, A_v, A_shift_k, A_ssm_k, A_ssm_D, B_x, B_w1, B_w2):
    def _A_ref(q, k, v, shift_k, ssm_k, ssm_D):
        B, S, D = q.shape
        ks = shift_k.shape[-1]
        k_pad = _pad(k, ((0, 0), (ks - 1, 0), (0, 0)))
        k_shift = torch.zeros_like(k)
        for t in range(ks):
            k_shift = k_shift + k_pad[:, t:t + S, :] * shift_k[:, ks - 1 - t][None, None, :]
        kv = k_shift * v
        L = 2 * S
        kv_pad = _pad(kv, ((0, 0), (0, S), (0, 0)))
        kf_pad = _pad(ssm_k, ((0, 0), (0, S)))
        kv_f = (lambda x, axes=(-2,-1): torch.fft.rfft2(x.float(), dim=axes))(kv_pad[:, None, :, :], axes=(1, 2))
        kf_f = (lambda x, axes=(-2,-1): torch.fft.rfft2(x.float(), dim=axes))(kf_pad[:, None, :], axes=(1, 2))
        kf_f = (lambda x, *d: x.permute(*d))(kf_f, 1, 2, 0)
        y_f = kv_f * kf_f[None, :, :, :]
        y = (lambda x, s, axes=(-2,-1): torch.fft.irfft2(x, s=s, dim=axes).to(torch.bfloat16))(y_f, (1, L), axes=(1, 2))[:, 0, :S, :]
        y = y + kv * ssm_D[None, None, :]
        return q * y

    def _B_ref(x, w1, w2):
        h = torch.einsum("bsd,df->bsf", x, w1)
        h = _silu(h)
        out = torch.einsum("bsf,fd->bsd", h, w2)
        return out

    x = A_q
    x = x + _A_ref(_layernorm(x, axis=-1), A_k, A_v, A_shift_k, A_ssm_k, A_ssm_D)
    x = x + _B_ref(_layernorm(x, axis=-1), B_w1, B_w2)
    x = x + _A_ref(_layernorm(x, axis=-1), A_k, A_v, A_shift_k, A_ssm_k, A_ssm_D)
    x = x + _B_ref(_layernorm(x, axis=-1), B_w1, B_w2)
    return x
```

```asm
; @launch grid=(256,1,1) block=(256,1,1) lds=163840
.amdgcn_target "amdgcn-amd-amdhsa--gfx950"
.text
.globl interleave_layers__ssm_conv_h3__dense_activation_silu__prompt_kernel
.p2align 8
.type interleave_layers__ssm_conv_h3__dense_activation_silu__prompt_kernel,@function
interleave_layers__ssm_conv_h3__dense_activation_silu__prompt_kernel:
    s_cmp_ge_u32 s2, 256
    s_cbranch_scc1 K_end
    s_load_dwordx16 s[16:31], s[0:1], 0
    s_load_dwordx8 s[32:39], s[0:1], 64
    s_memrealtime s[84:85]
    s_getpc_b64 s[90:91]
K_pc_1:
    v_lshlrev_b32 v180, 7, v0
    v_cmp_gt_u32 vcc, (K_end - K_pc_1), v180
    s_and_saveexec_b64 s[10:11], vcc
    global_load_dword v255, v180, s[90:91]
    s_mov_b64 exec, s[10:11]
    v_lshrrev_b32 v1, 6, v0
    s_nop 0
    v_readfirstlane_b32 s3, v1
    s_and_b32 s4, s2, 7
    s_lshr_b32 s5, s2, 3
    s_lshl_b32 s4, s4, 5
    s_add_u32 s4, s4, s5
    s_lshr_b32 s5, s4, 3
    s_and_b32 s6, s4, 7
    s_lshr_b32 s7, s3, 1
    s_and_b32 s8, s3, 1
    s_mov_b32 s87, 0
    s_mov_b32 s86, 0
    s_mul_i32 s100, s3, 7168
    s_mul_i32 s101, s3, 14336
    s_min_u32 s14, s2, 223
    s_mul_hi_u32 s12, s14, 0x24924925
    s_mul_i32 s13, s12, 7
    s_sub_u32 s13, s14, s13
    v_and_b32 v1, 15, v0
    v_lshrrev_b32 v2, 4, v0
    s_lshl_b32 s9, s12, 6
    s_sub_u32 s9, s9, 3
    v_lshl_add_u32 v3, v2, 2, s9
    v_mul_i32_i24 v4, 896, v3
    s_lshl_b32 s10, s13, 7
    v_lshl_add_u32 v5, v1, 3, s10
    v_add_u32 v4, v4, v5
    v_add_u32 v6, 896, v4
    v_add_u32 v7, 1792, v4
    v_add_u32 v8, 2688, v4
    v_add_u32 v9, 3584, v4
    v_add_u32 v10, 4480, v4
    v_add_u32 v11, 5376, v4
    v_lshlrev_b32 v12, 2, v5
    s_waitcnt lgkmcnt(0)
    s_sub_u32 s84, s84, 1200
    s_subb_u32 s85, s85, 0
    s_lshl_b64 s[84:85], s[84:85], 4
    s_or_b32 s85, s85, 0x40000000
    s_cmp_ge_u32 s2, 224
    s_cbranch_scc1 K_noprep
    s_mov_b32 s40, s18
    s_mov_b32 s41, s19
    s_mov_b32 s42, 0x1c0000
    s_mov_b32 s43, 0x20000
    buffer_load_dwordx2 v[16:17], v4, s[40:43], 0 offen
    buffer_load_dwordx2 v[18:19], v6, s[40:43], 0 offen
    buffer_load_dwordx2 v[20:21], v7, s[40:43], 0 offen
    buffer_load_dwordx2 v[22:23], v8, s[40:43], 0 offen
    buffer_load_dwordx2 v[24:25], v9, s[40:43], 0 offen
    buffer_load_dwordx2 v[26:27], v10, s[40:43], 0 offen
    buffer_load_dwordx2 v[28:29], v11, s[40:43], 0 offen
    s_mov_b32 s44, s20
    s_mov_b32 s45, s21
    s_mov_b32 s46, 0x1c0000
    s_mov_b32 s47, 0x20000
    buffer_load_dwordx2 v[30:31], v8, s[44:47], 0 offen
    buffer_load_dwordx2 v[32:33], v9, s[44:47], 0 offen
    buffer_load_dwordx2 v[34:35], v10, s[44:47], 0 offen
    buffer_load_dwordx2 v[36:37], v11, s[44:47], 0 offen
    s_mov_b32 s48, s22
    s_mov_b32 s49, s23
    s_mov_b32 s50, 0xe00
    s_mov_b32 s51, 0x20000
    buffer_load_dwordx4 v[38:41], v12, s[48:51], 0 offen
    buffer_load_dwordx4 v[42:45], v12, s[48:51], 0 offen offset:16
    s_cmp_eq_u32 s2, 0
    s_cbranch_scc0 nn_2
    s_cmp_eq_u32 s3, 0
    s_cbranch_scc0 nn_2
    s_mov_b32 s60, s36
    s_mov_b32 s61, s37
    s_mov_b32 s62, 0x100
    s_mov_b32 s63, 0x20000
    s_memrealtime s[10:11]
    s_waitcnt lgkmcnt(0)
    s_lshl_b64 s[10:11], s[10:11], 4
    s_or_b32 s11, s11, 0x40000000
    v_mov_b32 v46, s10
    v_mov_b32 v47, s11
    v_mov_b32 v13, 0
    s_mov_b64 exec, 1
    buffer_store_dwordx2 v[46:47], v13, s[60:63], 0 offen sc1
    s_mov_b64 exec, -1
nn_2:
    s_mov_b32 s52, s38
    s_mov_b32 s53, s39
    s_mov_b32 s54, 0x1c0000
    s_mov_b32 s55, 0x20000
    s_add_u32 s64, s38, 0x2800000
    s_addc_u32 s65, s39, 0
    s_mov_b32 s66, 0x14000
    s_mov_b32 s67, 0x20000
    s_cmp_ge_u32 s2, 112
    s_cselect_b32 s74, 1, 0
    s_cselect_b32 s9, 112, 0
    s_sub_u32 s9, s2, s9
    s_mul_hi_u32 s72, s9, 0x12492493
    s_mul_i32 s10, s72, 14
    s_sub_u32 s73, s9, s10
    s_mul_i32 s10, s73, 114688
    s_mul_i32 s11, s72, 448
    s_add_u32 s10, s10, s11
    s_lshr_b32 s11, s73, 1
    s_mul_i32 s11, s11, 28672
    s_mul_i32 s14, s72, 200704
    s_add_u32 s11, s11, s14
    s_and_b32 s14, s73, 1
    s_mul_i32 s14, s14, 448
    s_add_u32 s11, s11, s14
    s_cmp_eq_u32 s74, 1
    s_cselect_b32 s10, s11, s10
    s_mov_b32 s75, 3584
    s_cselect_b32 s75, 896, s75
    s_cselect_b32 s56, s32, s30
    s_cselect_b32 s57, s33, s31
    s_mov_b32 s58, 0x188000
    s_mov_b32 s59, 0x20000
    v_add_u32 v13, 0, v0
    v_mul_u32_u24 v14, 2341, v13
    v_lshrrev_b32 v14, 16, v14
    v_mul_u32_u24 v15, 28, v14
    v_sub_u32 v15, v13, v15
    v_mul_lo_u32 v14, v14, s75
    v_lshl_add_u32 v14, v15, 4, v14
    v_add_u32 v14, s10, v14
    buffer_load_dwordx4 v[48:51], v14, s[56:59], 0 offen
    v_add_u32 v13, 256, v0
    v_mul_u32_u24 v14, 2341, v13
    v_lshrrev_b32 v14, 16, v14
    v_mul_u32_u24 v15, 28, v14
    v_sub_u32 v15, v13, v15
    v_mul_lo_u32 v14, v14, s75
    v_lshl_add_u32 v14, v15, 4, v14
    v_add_u32 v14, s10, v14
    buffer_load_dwordx4 v[52:55], v14, s[56:59], 0 offen
    v_add_u32 v13, 512, v0
    v_mul_u32_u24 v14, 2341, v13
    v_lshrrev_b32 v14, 16, v14
    v_mul_u32_u24 v15, 28, v14
    v_sub_u32 v15, v13, v15
    v_mul_lo_u32 v14, v14, s75
    v_lshl_add_u32 v14, v15, 4, v14
    v_add_u32 v14, s10, v14
    buffer_load_dwordx4 v[56:59], v14, s[56:59], 0 offen
    v_add_u32 v13, 768, v0
    v_mul_u32_u24 v14, 2341, v13
    v_lshrrev_b32 v14, 16, v14
    v_mul_u32_u24 v15, 28, v14
    v_sub_u32 v15, v13, v15
    v_mul_lo_u32 v14, v14, s75
    v_lshl_add_u32 v14, v15, 4, v14
    v_add_u32 v14, s10, v14
    v_cmp_gt_u32 vcc, 896, v13
    s_nop 1
    v_cndmask_b32 v14, -1, v14, vcc
    buffer_load_dwordx4 v[60:63], v14, s[56:59], 0 offen
    v_and_b32 v46, 63, v0
    v_lshrrev_b32 v47, 4, v46
    v_bfe_u32 v14, v46, 2, 2
    v_and_b32 v15, 3, v46
    v_lshl_add_u32 v47, v47, 3, v14
    v_mul_u32_u24 v47, 448, v47
    v_lshlrev_b32 v46, 4, v46
    s_cmp_eq_u32 s74, 1
    s_mov_b32 s9, 0x800000
    s_cselect_b32 s9, 0xa00000, s9
    s_add_u32 s68, s38, s9
    s_addc_u32 s69, s39, 0
    s_mov_b32 s70, 0x188000
    s_mov_b32 s71, 0x20000
    s_add_u32 s14, s3, 0
    s_cmp_ge_u32 s14, 7
    s_cselect_b32 s76, 1, 0
    s_mul_i32 s77, s76, 7
    s_sub_u32 s77, s14, s77
    s_mul_i32 s80, s72, 7
    s_add_u32 s80, s80, s77
    s_lshl_b32 s80, s80, 1
    s_add_u32 s80, s80, s76
    s_mul_i32 s80, s80, 14
    s_add_u32 s80, s80, s73
    s_and_b32 s9, s14, 1
    s_lshr_b32 s10, s14, 1
    s_and_b32 s11, s73, 1
    s_mul_i32 s11, s11, 7
    s_add_u32 s11, s11, s10
    s_lshr_b32 s15, s73, 1
    s_mul_i32 s15, s15, 7
    s_mul_i32 s76, s72, 196
    s_add_u32 s15, s15, s76
    s_and_b32 s76, s11, 3
    s_mul_i32 s76, s76, 49
    s_lshr_b32 s77, s11, 2
    s_lshl_b32 s77, s77, 1
    s_add_u32 s77, s77, s9
    s_add_u32 s76, s76, s77
    s_lshl_b32 s10, s10, 6
    s_lshl_b32 s77, s9, 3
    s_add_u32 s77, s77, s10
    s_sub_u32 s78, s11, 12
    s_lshl_b32 s78, s78, 1
    s_add_u32 s78, s78, s9
    s_mul_i32 s78, s78, 49
    s_add_u32 s78, s78, 6
    s_lshl_b32 s79, s9, 5
    s_add_u32 s79, s79, s10
    s_cmp_lt_u32 s11, 12
    s_cselect_b32 s76, s76, s78
    s_cselect_b32 s77, s77, s79
    s_cselect_b32 s78, 4, 3
    s_add_u32 s76, s76, s15
    s_lshl_b32 s79, s14, 5
    s_cmp_eq_u32 s74, 1
    s_cselect_b32 s80, s76, s80
    s_cselect_b32 s77, s77, s79
    s_cselect_b32 s78, s78, 3
    s_lshl_b32 s80, s80, 10
    v_lshlrev_b32 v144, s78, v15
    v_add3_u32 v144, v144, v47, s77
    s_add_u32 s14, s3, 4
    s_cmp_ge_u32 s14, 7
    s_cselect_b32 s76, 1, 0
    s_mul_i32 s77, s76, 7
    s_sub_u32 s77, s14, s77
    s_mul_i32 s81, s72, 7
    s_add_u32 s81, s81, s77
    s_lshl_b32 s81, s81, 1
    s_add_u32 s81, s81, s76
    s_mul_i32 s81, s81, 14
    s_add_u32 s81, s81, s73
    s_and_b32 s9, s14, 1
    s_lshr_b32 s10, s14, 1
    s_and_b32 s11, s73, 1
    s_mul_i32 s11, s11, 7
    s_add_u32 s11, s11, s10
    s_lshr_b32 s15, s73, 1
    s_mul_i32 s15, s15, 7
    s_mul_i32 s76, s72, 196
    s_add_u32 s15, s15, s76
    s_and_b32 s76, s11, 3
    s_mul_i32 s76, s76, 49
    s_lshr_b32 s77, s11, 2
    s_lshl_b32 s77, s77, 1
    s_add_u32 s77, s77, s9
    s_add_u32 s76, s76, s77
    s_lshl_b32 s10, s10, 6
    s_lshl_b32 s77, s9, 3
    s_add_u32 s77, s77, s10
    s_sub_u32 s78, s11, 12
    s_lshl_b32 s78, s78, 1
    s_add_u32 s78, s78, s9
    s_mul_i32 s78, s78, 49
    s_add_u32 s78, s78, 6
    s_lshl_b32 s79, s9, 5
    s_add_u32 s79, s79, s10
    s_cmp_lt_u32 s11, 12
    s_cselect_b32 s76, s76, s78
    s_cselect_b32 s77, s77, s79
    s_cselect_b32 s78, 4, 3
    s_add_u32 s76, s76, s15
    s_lshl_b32 s79, s14, 5
    s_cmp_eq_u32 s74, 1
    s_cselect_b32 s81, s76, s81
    s_cselect_b32 s77, s77, s79
    s_cselect_b32 s78, s78, 3
    s_lshl_b32 s81, s81, 10
    v_lshlrev_b32 v145, s78, v15
    v_add3_u32 v145, v145, v47, s77
    s_add_u32 s14, s3, 8
    s_cmp_ge_u32 s14, 7
    s_cselect_b32 s76, 1, 0
    s_mul_i32 s77, s76, 7
    s_sub_u32 s77, s14, s77
    s_mul_i32 s82, s72, 7
    s_add_u32 s82, s82, s77
    s_lshl_b32 s82, s82, 1
    s_add_u32 s82, s82, s76
    s_mul_i32 s82, s82, 14
    s_add_u32 s82, s82, s73
    s_and_b32 s9, s14, 1
    s_lshr_b32 s10, s14, 1
    s_and_b32 s11, s73, 1
    s_mul_i32 s11, s11, 7
    s_add_u32 s11, s11, s10
    s_lshr_b32 s15, s73, 1
    s_mul_i32 s15, s15, 7
    s_mul_i32 s76, s72, 196
    s_add_u32 s15, s15, s76
    s_and_b32 s76, s11, 3
    s_mul_i32 s76, s76, 49
    s_lshr_b32 s77, s11, 2
    s_lshl_b32 s77, s77, 1
    s_add_u32 s77, s77, s9
    s_add_u32 s76, s76, s77
    s_lshl_b32 s10, s10, 6
    s_lshl_b32 s77, s9, 3
    s_add_u32 s77, s77, s10
    s_sub_u32 s78, s11, 12
    s_lshl_b32 s78, s78, 1
    s_add_u32 s78, s78, s9
    s_mul_i32 s78, s78, 49
    s_add_u32 s78, s78, 6
    s_lshl_b32 s79, s9, 5
    s_add_u32 s79, s79, s10
    s_cmp_lt_u32 s11, 12
    s_cselect_b32 s76, s76, s78
    s_cselect_b32 s77, s77, s79
    s_cselect_b32 s78, 4, 3
    s_add_u32 s76, s76, s15
    s_lshl_b32 s79, s14, 5
    s_cmp_eq_u32 s74, 1
    s_cselect_b32 s82, s76, s82
    s_cselect_b32 s77, s77, s79
    s_cselect_b32 s78, s78, 3
    s_lshl_b32 s82, s82, 10
    v_lshlrev_b32 v146, s78, v15
    v_add3_u32 v146, v146, v47, s77
    s_add_u32 s14, s3, 12
    s_cmp_ge_u32 s14, 7
    s_cselect_b32 s76, 1, 0
    s_mul_i32 s77, s76, 7
    s_sub_u32 s77, s14, s77
    s_mul_i32 s83, s72, 7
    s_add_u32 s83, s83, s77
    s_lshl_b32 s83, s83, 1
    s_add_u32 s83, s83, s76
    s_mul_i32 s83, s83, 14
    s_add_u32 s83, s83, s73
    s_and_b32 s9, s14, 1
    s_lshr_b32 s10, s14, 1
    s_and_b32 s11, s73, 1
    s_mul_i32 s11, s11, 7
    s_add_u32 s11, s11, s10
    s_lshr_b32 s15, s73, 1
    s_mul_i32 s15, s15, 7
    s_mul_i32 s76, s72, 196
    s_add_u32 s15, s15, s76
    s_and_b32 s76, s11, 3
    s_mul_i32 s76, s76, 49
    s_lshr_b32 s77, s11, 2
    s_lshl_b32 s77, s77, 1
    s_add_u32 s77, s77, s9
    s_add_u32 s76, s76, s77
    s_lshl_b32 s10, s10, 6
    s_lshl_b32 s77, s9, 3
    s_add_u32 s77, s77, s10
    s_sub_u32 s78, s11, 12
    s_lshl_b32 s78, s78, 1
    s_add_u32 s78, s78, s9
    s_mul_i32 s78, s78, 49
    s_add_u32 s78, s78, 6
    s_lshl_b32 s79, s9, 5
    s_add_u32 s79, s79, s10
    s_cmp_lt_u32 s11, 12
    s_cselect_b32 s76, s76, s78
    s_cselect_b32 s77, s77, s79
    s_cselect_b32 s78, 4, 3
    s_add_u32 s76, s76, s15
    s_lshl_b32 s79, s14, 5
    s_cmp_eq_u32 s74, 1
    s_cselect_b32 s83, s76, s83
    s_cselect_b32 s77, s77, s79
    s_cselect_b32 s78, s78, 3
    s_lshl_b32 s83, s83, 10
    v_lshlrev_b32 v147, s78, v15
    v_add3_u32 v147, v147, v47, s77
    v_and_b32 v181, 31, v0
    v_lshrrev_b32 v182, 5, v0
    v_cmp_gt_u32 s[88:89], 28, v181
    v_mul_u32_u24 v183, 896, v182
    v_lshl_add_u32 v183, v181, 4, v183
    s_mul_i32 s9, s4, 7168
    v_add_u32 v183, s9, v183
    v_cndmask_b32 v248, -1, v183, s[88:89]
    v_add_u32 v183, 448, v183
    v_cndmask_b32 v249, -1, v183, s[88:89]
    v_and_b32 v181, 63, v0
    v_and_b32 v182, 15, v181
    v_lshrrev_b32 v183, 4, v181
    s_mul_i32 s9, s7, 14336
    s_add_u32 s9, s9, 57344
    v_lshl_add_u32 v202, v181, 4, s9
    v_add_u32 v203, 57344, v202
    s_lshl_b32 s9, s8, 5
    v_add_u32 v184, s9, v182
    v_mul_u32_u24 v184, 448, v184
    v_bfe_u32 v185, v182, 1, 2
    v_lshrrev_b32 v186, 1, v183
    v_xor_b32 v186, v186, v185
    v_lshl_add_u32 v184, v186, 4, v184
    v_and_b32 v186, 1, v183
    v_lshl_add_u32 v184, v186, 3, v184
    v_xor_b32 v186, 32, v184
    s_cmp_eq_u32 s7, 1
    s_cselect_b64 vcc, -1, 0
    v_add_u32 v187, 192, v186
    v_cndmask_b32 v204, v184, v187, vcc
    v_add_u32 v187, 256, v184
    v_cndmask_b32 v218, v186, v187, vcc
    v_mul_u32_u24 v184, 448, v182
    v_xor_b32 v185, v185, v183
    v_lshl_add_u32 v205, v185, 4, v184
    v_subrev_u32 v219, 28672, v202
    v_lshlrev_b32 v206, 4, v181
    v_mul_u32_u24 v184, 896, v182
    s_lshl_b32 s9, s3, 6
    v_lshl_add_u32 v185, v183, 4, v184
    v_add_u32 v207, s9, v185
    s_add_u32 s9, s7, 12
    s_lshl_b32 s9, s9, 6
    s_lshl_b32 s10, s8, 5
    s_add_u32 s9, s9, s10
    v_lshl_add_u32 v185, v183, 3, v184
    v_add_u32 v208, s9, v185
    v_and_b32 v181, 63, v0
    v_lshrrev_b32 v182, 5, v181
    v_and_b32 v183, 31, v181
    v_add_u32 v184, 0, v182
    v_xor_b32 v185, v183, v184
    v_mul_u32_u24 v184, 896, v184
    v_lshl_add_u32 v200, v185, 4, v184
    v_add_u32 v184, 2, v182
    v_xor_b32 v185, v183, v184
    v_mul_u32_u24 v184, 896, v184
    v_lshl_add_u32 v201, v185, 4, v184
    v_add_u32 v184, 4, v182
    v_xor_b32 v185, v183, v184
    v_mul_u32_u24 v184, 896, v184
    v_lshl_add_u32 v209, v185, 4, v184
    v_add_u32 v184, 6, v182
    v_xor_b32 v185, v183, v184
    v_mul_u32_u24 v184, 896, v184
    v_lshl_add_u32 v210, v185, 4, v184
    v_add_u32 v184, 8, v182
    v_xor_b32 v185, v183, v184
    v_mul_u32_u24 v184, 896, v184
    v_lshl_add_u32 v211, v185, 4, v184
    v_add_u32 v184, 10, v182
    v_xor_b32 v185, v183, v184
    v_mul_u32_u24 v184, 896, v184
    v_lshl_add_u32 v212, v185, 4, v184
    v_add_u32 v184, 12, v182
    v_xor_b32 v185, v183, v184
    v_mul_u32_u24 v184, 896, v184
    v_lshl_add_u32 v213, v185, 4, v184
    v_add_u32 v184, 14, v182
    v_xor_b32 v185, v183, v184
    v_mul_u32_u24 v184, 896, v184
    v_lshl_add_u32 v214, v185, 4, v184
    v_add_u32 v184, 0, v181
    v_mul_u32_u24 v185, 2731, v184
    v_lshrrev_b32 v185, 16, v185
    v_mul_u32_u24 v186, 24, v185
    v_sub_u32 v186, v184, v186
    v_and_b32 v184, 6, v185
    v_xor_b32 v186, v186, v184
    v_mul_u32_u24 v185, 896, v185
    v_lshl_add_u32 v185, v186, 4, v185
    v_add_u32 v215, 512, v185
    v_add_u32 v184, 64, v181
    v_mul_u32_u24 v185, 2731, v184
    v_lshrrev_b32 v185, 16, v185
    v_mul_u32_u24 v186, 24, v185
    v_sub_u32 v186, v184, v186
    v_and_b32 v184, 6, v185
    v_xor_b32 v186, v186, v184
    v_mul_u32_u24 v185, 896, v185
    v_lshl_add_u32 v185, v186, 4, v185
    v_add_u32 v216, 512, v185
    v_add_u32 v184, 128, v181
    v_mul_u32_u24 v185, 2731, v184
    v_lshrrev_b32 v185, 16, v185
    v_mul_u32_u24 v186, 24, v185
    v_sub_u32 v186, v184, v186
    v_and_b32 v184, 6, v185
    v_xor_b32 v186, v186, v184
    v_mul_u32_u24 v185, 896, v185
    v_lshl_add_u32 v185, v186, 4, v185
    v_add_u32 v217, 512, v185
    v_add_u32 v184, 192, v181
    v_mul_u32_u24 v185, 2731, v184
    v_lshrrev_b32 v185, 16, v185
    v_mul_u32_u24 v186, 24, v185
    v_sub_u32 v186, v184, v186
    v_and_b32 v184, 6, v185
    v_xor_b32 v186, v186, v184
    v_mul_u32_u24 v185, 896, v185
    v_lshl_add_u32 v185, v186, 4, v185
    v_add_u32 v220, 512, v185
    v_add_u32 v184, 256, v181
    v_mul_u32_u24 v185, 2731, v184
    v_lshrrev_b32 v185, 16, v185
    v_mul_u32_u24 v186, 24, v185
    v_sub_u32 v186, v184, v186
    v_and_b32 v184, 6, v185
    v_xor_b32 v186, v186, v184
    v_mul_u32_u24 v185, 896, v185
    v_lshl_add_u32 v185, v186, 4, v185
    v_add_u32 v221, 512, v185
    v_add_u32 v184, 320, v181
    v_mul_u32_u24 v185, 2731, v184
    v_lshrrev_b32 v185, 16, v185
    v_mul_u32_u24 v186, 24, v185
    v_sub_u32 v186, v184, v186
    v_and_b32 v184, 6, v185
    v_xor_b32 v186, v186, v184
    v_mul_u32_u24 v185, 896, v185
    v_lshl_add_u32 v185, v186, 4, v185
    v_add_u32 v222, 512, v185
    s_waitcnt vmcnt(0)
    s_lshl_b32 s9, s2, 13
    s_add_u32 s60, s24, s9
    s_addc_u32 s61, s25, 0
    s_mov_b32 s62, 8192
    s_mov_b32 s63, 0x20000
    v_sub_u32 v176, 255, v0
    v_lshlrev_b32 v176, 4, v176
    v_subrev_u32 v177, 16, v176
    v_add_u32 v178, 0, v177
    v_add_u32 v179, 0, v176
    buffer_load_dwordx4 v[160:163], v178, s[60:63], 0 offen
    buffer_load_dwordx4 v[164:167], v179, s[60:63], 0 offen
    v_add_u32 v178, 4096, v177
    v_add_u32 v179, 4096, v176
    buffer_load_dwordx4 v[168:171], v178, s[60:63], 0 offen
    buffer_load_dwordx4 v[172:175], v179, s[60:63], 0 offen
    s_mov_b32 s60, s16
    s_mov_b32 s61, s17
    s_mov_b32 s62, 0x1c0000
    s_mov_b32 s63, 0x20000
    buffer_load_dwordx4 v[224:227], v248, s[60:63], 0 offen
    buffer_load_dwordx4 v[228:231], v249, s[60:63], 0 offen
    v_lshlrev_b32 v14, 4, v0
    ds_write_b128 v14, v[48:51] offset:8192
    ds_write_b128 v14, v[52:55] offset:12288
    ds_write_b128 v14, v[56:59] offset:16384
    s_cmp_ge_u32 s3, 2
    s_cbranch_scc1 skip3_3
    ds_write_b128 v14, v[60:63] offset:20480
skip3_3:
    s_waitcnt lgkmcnt(0)
    s_barrier
    ds_read_b64_tr_b16 v[48:49], v144 offset:8192
    ds_read_b64_tr_b16 v[50:51], v144 offset:9984
    ds_read_b64_tr_b16 v[52:53], v145 offset:8192
    ds_read_b64_tr_b16 v[54:55], v145 offset:9984
    ds_read_b64_tr_b16 v[56:57], v146 offset:8192
    ds_read_b64_tr_b16 v[58:59], v146 offset:9984
    ds_read_b64_tr_b16 v[60:61], v147 offset:8192
    ds_read_b64_tr_b16 v[62:63], v147 offset:9984
    s_waitcnt lgkmcnt(6)
    buffer_store_dwordx4 v[48:51], v46, s[68:71], s80 offen sc1
    s_waitcnt lgkmcnt(4)
    buffer_store_dwordx4 v[52:55], v46, s[68:71], s81 offen sc1
    s_waitcnt lgkmcnt(2)
    buffer_store_dwordx4 v[56:59], v46, s[68:71], s82 offen sc1
    s_waitcnt lgkmcnt(0)
    s_cmp_ge_u32 s3, 2
    s_cbranch_scc1 pk_4
    buffer_store_dwordx4 v[60:63], v46, s[68:71], s83 offen sc1
pk_4:
    s_mov_b32 s60, s36
    s_mov_b32 s61, s37
    s_mov_b32 s62, 0x100
    s_mov_b32 s63, 0x20000
    v_mov_b32 v47, 0
    buffer_load_dwordx2 v[150:151], v47, s[60:63], 0 offen sc1
    v_mov_b32 v15, 0xffff0000
    v_lshlrev_b32 v64, 16, v16
    v_and_b32 v65, v15, v16
    v_lshlrev_b32 v66, 16, v17
    v_and_b32 v67, v15, v17
    v_lshlrev_b32 v68, 16, v18
    v_and_b32 v69, v15, v18
    v_lshlrev_b32 v70, 16, v19
    v_and_b32 v71, v15, v19
    v_lshlrev_b32 v72, 16, v20
    v_and_b32 v73, v15, v20
    v_lshlrev_b32 v74, 16, v21
    v_and_b32 v75, v15, v21
    v_lshlrev_b32 v76, 16, v22
    v_and_b32 v77, v15, v22
    v_lshlrev_b32 v78, 16, v23
    v_and_b32 v79, v15, v23
    v_lshlrev_b32 v80, 16, v24
    v_and_b32 v81, v15, v24
    v_lshlrev_b32 v82, 16, v25
    v_and_b32 v83, v15, v25
    v_lshlrev_b32 v84, 16, v26
    v_and_b32 v85, v15, v26
    v_lshlrev_b32 v86, 16, v27
    v_and_b32 v87, v15, v27
    v_lshlrev_b32 v88, 16, v28
    v_and_b32 v89, v15, v28
    v_lshlrev_b32 v90, 16, v29
    v_and_b32 v91, v15, v29
    v_lshlrev_b32 v92, 16, v38
    v_and_b32 v96, v15, v38
    v_lshlrev_b32 v100, 16, v39
    v_and_b32 v104, v15, v39
    v_lshlrev_b32 v93, 16, v40
    v_and_b32 v97, v15, v40
    v_lshlrev_b32 v101, 16, v41
    v_and_b32 v105, v15, v41
    v_lshlrev_b32 v94, 16, v42
    v_and_b32 v98, v15, v42
    v_lshlrev_b32 v102, 16, v43
    v_and_b32 v106, v15, v43
    v_lshlrev_b32 v95, 16, v44
    v_and_b32 v99, v15, v44
    v_lshlrev_b32 v103, 16, v45
    v_and_b32 v107, v15, v45
    v_lshlrev_b32 v108, 16, v30
    v_and_b32 v109, v15, v30
    v_lshlrev_b32 v110, 16, v31
    v_and_b32 v111, v15, v31
    v_lshlrev_b32 v112, 16, v32
    v_and_b32 v113, v15, v32
    v_lshlrev_b32 v114, 16, v33
    v_and_b32 v115, v15, v33
    v_lshlrev_b32 v116, 16, v34
    v_and_b32 v117, v15, v34
    v_lshlrev_b32 v118, 16, v35
    v_and_b32 v119, v15, v35
    v_lshlrev_b32 v120, 16, v36
    v_and_b32 v121, v15, v36
    v_lshlrev_b32 v122, 16, v37
    v_and_b32 v123, v15, v37
    v_pk_mul_f32 v[124:125], v[76:77], v[92:93]
    v_pk_mul_f32 v[126:127], v[78:79], v[94:95]
    v_pk_mul_f32 v[128:129], v[80:81], v[92:93]
    v_pk_mul_f32 v[130:131], v[82:83], v[94:95]
    v_pk_mul_f32 v[132:133], v[84:85], v[92:93]
    v_pk_mul_f32 v[134:135], v[86:87], v[94:95]
    v_pk_mul_f32 v[136:137], v[88:89], v[92:93]
    v_pk_mul_f32 v[138:139], v[90:91], v[94:95]
    v_pk_fma_f32 v[124:125], v[72:73], v[96:97], v[124:125]
    v_pk_fma_f32 v[126:127], v[74:75], v[98:99], v[126:127]
    v_pk_fma_f32 v[128:129], v[76:77], v[96:97], v[128:129]
    v_pk_fma_f32 v[130:131], v[78:79], v[98:99], v[130:131]
    v_pk_fma_f32 v[132:133], v[80:81], v[96:97], v[132:133]
    v_pk_fma_f32 v[134:135], v[82:83], v[98:99], v[134:135]
    v_pk_fma_f32 v[136:137], v[84:85], v[96:97], v[136:137]
    v_pk_fma_f32 v[138:139], v[86:87], v[98:99], v[138:139]
    v_pk_fma_f32 v[124:125], v[68:69], v[100:101], v[124:125]
    v_pk_fma_f32 v[126:127], v[70:71], v[102:103], v[126:127]
    v_pk_fma_f32 v[128:129], v[72:73], v[100:101], v[128:129]
    v_pk_fma_f32 v[130:131], v[74:75], v[102:103], v[130:131]
    v_pk_fma_f32 v[132:133], v[76:77], v[100:101], v[132:133]
    v_pk_fma_f32 v[134:135], v[78:79], v[102:103], v[134:135]
    v_pk_fma_f32 v[136:137], v[80:81], v[100:101], v[136:137]
    v_pk_fma_f32 v[138:139], v[82:83], v[102:103], v[138:139]
    v_pk_fma_f32 v[124:125], v[64:65], v[104:105], v[124:125]
    v_pk_fma_f32 v[126:127], v[66:67], v[106:107], v[126:127]
    v_pk_fma_f32 v[128:129], v[68:69], v[104:105], v[128:129]
    v_pk_fma_f32 v[130:131], v[70:71], v[106:107], v[130:131]
    v_pk_fma_f32 v[132:133], v[72:73], v[104:105], v[132:133]
    v_pk_fma_f32 v[134:135], v[74:75], v[106:107], v[134:135]
    v_pk_fma_f32 v[136:137], v[76:77], v[104:105], v[136:137]
    v_pk_fma_f32 v[138:139], v[78:79], v[106:107], v[138:139]
    v_pk_mul_f32 v[124:125], v[124:125], v[108:109]
    v_pk_mul_f32 v[126:127], v[126:127], v[110:111]
    v_pk_mul_f32 v[128:129], v[128:129], v[112:113]
    v_pk_mul_f32 v[130:131], v[130:131], v[114:115]
    v_pk_mul_f32 v[132:133], v[132:133], v[116:117]
    v_pk_mul_f32 v[134:135], v[134:135], v[118:119]
    v_pk_mul_f32 v[136:137], v[136:137], v[120:121]
    v_pk_mul_f32 v[138:139], v[138:139], v[122:123]
    v_cvt_pk_bf16_f32 v140, v124, v128
    v_cvt_pk_bf16_f32 v141, v132, v136
    v_cvt_pk_bf16_f32 v142, v125, v129
    v_cvt_pk_bf16_f32 v143, v133, v137
    v_cvt_pk_bf16_f32 v144, v126, v130
    v_cvt_pk_bf16_f32 v145, v134, v138
    v_cvt_pk_bf16_f32 v146, v127, v131
    v_cvt_pk_bf16_f32 v147, v135, v139
    v_xor_b32 v13, v1, v2
    v_lshlrev_b32 v13, 3, v13
    v_lshl_add_u32 v13, v1, 9, v13
    ds_write_b64 v13, v[140:141] offset:0
    ds_write_b64 v13, v[142:143] offset:128
    ds_write_b64 v13, v[144:145] offset:256
    ds_write_b64 v13, v[146:147] offset:384
    s_waitcnt lgkmcnt(0)
    s_barrier
    v_lshrrev_b32 v1, 3, v0
    v_and_b32 v2, 7, v0
    v_lshlrev_b32 v3, 1, v2
    s_lshl_b32 s9, s13, 6
    s_lshl_b32 s10, s12, 7
    v_add_u32 v4, 0, v1
    v_lshrrev_b32 v5, 2, v4
    v_xor_b32 v6, v3, v5
    v_xor_b32 v7, 1, v6
    v_lshlrev_b32 v8, 7, v4
    v_lshl_add_u32 v6, v6, 3, v8
    v_lshl_add_u32 v7, v7, 3, v8
    ds_read_b64 v[16:17], v6 offset:0
    ds_read_b64 v[18:19], v7 offset:0
    v_add_u32 v8, s9, v4
    v_lshlrev_b32 v8, 12, v8
    v_lshl_add_u32 v8, v2, 4, v8
    v_add_u32 v24, s10, v8
    v_add_u32 v4, 32, v1
    v_lshrrev_b32 v5, 2, v4
    v_xor_b32 v6, v3, v5
    v_xor_b32 v7, 1, v6
    v_lshlrev_b32 v8, 7, v4
    v_lshl_add_u32 v6, v6, 3, v8
    v_lshl_add_u32 v7, v7, 3, v8
    ds_read_b64 v[20:21], v6 offset:0
    ds_read_b64 v[22:23], v7 offset:0
    v_add_u32 v8, s9, v4
    v_lshlrev_b32 v8, 12, v8
    v_lshl_add_u32 v8, v2, 4, v8
    v_add_u32 v25, s10, v8
    s_waitcnt lgkmcnt(2)
    buffer_store_dwordx4 v[16:19], v24, s[52:55], 0 offen sc1
    s_waitcnt lgkmcnt(0)
    buffer_store_dwordx4 v[20:23], v25, s[52:55], 0 offen sc1
    s_waitcnt vmcnt(0)
    v_readfirstlane_b32 s10, v150
    v_readfirstlane_b32 s11, v151
    s_nop 3
    s_sub_u32 s9, s10, s84
    s_subb_u32 s9, s11, s85
    s_cbranch_scc1 stale_6
    s_mov_b64 s[84:85], s[10:11]
    s_branch haven_5
stale_6:
    s_mov_b32 s60, s36
    s_mov_b32 s61, s37
    s_mov_b32 s62, 0x100
    s_mov_b32 s63, 0x20000
    s_mov_b32 s90, 0
non_7:
    v_mov_b32 v1, 0
    buffer_load_dwordx2 v[2:3], v1, s[60:63], 0 offen sc1
    s_waitcnt vmcnt(0)
    v_readfirstlane_b32 s10, v2
    v_readfirstlane_b32 s11, v3
    s_nop 3
    s_sub_u32 s9, s10, s84
    s_subb_u32 s9, s11, s85
    s_cbranch_scc1 stale_8
    s_mov_b64 s[84:85], s[10:11]
    s_branch haven_5
stale_8:
    s_add_u32 s90, s90, 1
    s_sleep 1
    s_cmp_lt_u32 s90, 0x40000
    s_cbranch_scc1 non_7
    s_mov_b64 s[84:85], s[10:11]
haven_5:
    s_barrier
    s_cmp_eq_u32 s3, 0
    s_cbranch_scc0 sigr_9
    s_lshl_b32 s90, s2, 3
    s_add_u32 s90, s90, 16384
    v_mov_b32 v250, s84
    v_mov_b32 v251, s85
    v_lshlrev_b32 v1, 11, v0
    v_add_u32 v1, s90, v1
    s_mov_b64 exec, 0xff
    buffer_store_dwordx2 v[250:251], v1, s[64:67], 0 offen sc1
    s_mov_b64 exec, -1
sigr_9:
    s_waitcnt vmcnt(0)
    v_mov_b32 v5, 0xffff
    v_cmp_ne_u32 vcc, 255, v0
    v_lshlrev_b32 v6, 4, v0
    s_nop 0
    v_cndmask_b32 v160, 0, v160, vcc
    v_cndmask_b32 v161, 0, v161, vcc
    v_cndmask_b32 v162, 0, v162, vcc
    v_cndmask_b32 v163, 0, v163, vcc
    v_alignbit_b32 v32, v167, v167, 16
    v_alignbit_b32 v33, v166, v166, 16
    v_alignbit_b32 v34, v165, v165, 16
    v_alignbit_b32 v35, v164, v164, 16
    v_alignbit_b32 v36, v163, v163, 16
    v_alignbit_b32 v37, v162, v162, 16
    v_alignbit_b32 v38, v161, v161, 16
    v_alignbit_b32 v40, v166, v166, 16
    v_alignbit_b32 v41, v165, v165, 16
    v_alignbit_b32 v42, v164, v164, 16
    v_alignbit_b32 v43, v163, v163, 16
    v_alignbit_b32 v44, v162, v162, 16
    v_alignbit_b32 v45, v161, v161, 16
    v_bfi_b32 v46, v5, v167, v166
    v_bfi_b32 v47, v5, v166, v165
    v_bfi_b32 v48, v5, v165, v164
    v_bfi_b32 v49, v5, v164, v163
    v_bfi_b32 v50, v5, v163, v162
    v_bfi_b32 v51, v5, v162, v161
    v_bfi_b32 v52, v5, v161, v160
    v_bfi_b32 v54, v5, v166, v165
    v_bfi_b32 v55, v5, v165, v164
    v_bfi_b32 v56, v5, v164, v163
    v_bfi_b32 v57, v5, v163, v162
    v_bfi_b32 v58, v5, v162, v161
    v_bfi_b32 v59, v5, v161, v160
    ds_write_b128 v6, v[32:35] offset:0
    ds_write_b128 v6, v[46:49] offset:4160
    ds_write_b128 v6, v[40:43] offset:8320
    ds_write_b128 v6, v[54:57] offset:12480
    ds_write_b128 v6, v[34:37] offset:16640
    ds_write_b128 v6, v[48:51] offset:20800
    ds_write_b128 v6, v[42:45] offset:24960
    ds_write_b128 v6, v[56:59] offset:29120
    s_nop 1
    v_cndmask_b32 v168, 0, v168, vcc
    v_cndmask_b32 v169, 0, v169, vcc
    v_cndmask_b32 v170, 0, v170, vcc
    v_cndmask_b32 v171, 0, v171, vcc
    v_alignbit_b32 v32, v175, v175, 16
    v_alignbit_b32 v33, v174, v174, 16
    v_alignbit_b32 v34, v173, v173, 16
    v_alignbit_b32 v35, v172, v172, 16
    v_alignbit_b32 v36, v171, v171, 16
    v_alignbit_b32 v37, v170, v170, 16
    v_alignbit_b32 v38, v169, v169, 16
    v_alignbit_b32 v40, v174, v174, 16
    v_alignbit_b32 v41, v173, v173, 16
    v_alignbit_b32 v42, v172, v172, 16
    v_alignbit_b32 v43, v171, v171, 16
    v_alignbit_b32 v44, v170, v170, 16
    v_alignbit_b32 v45, v169, v169, 16
    v_bfi_b32 v46, v5, v175, v174
    v_bfi_b32 v47, v5, v174, v173
    v_bfi_b32 v48, v5, v173, v172
    v_bfi_b32 v49, v5, v172, v171
    v_bfi_b32 v50, v5, v171, v170
    v_bfi_b32 v51, v5, v170, v169
    v_bfi_b32 v52, v5, v169, v168
    v_bfi_b32 v54, v5, v174, v173
    v_bfi_b32 v55, v5, v173, v172
    v_bfi_b32 v56, v5, v172, v171
    v_bfi_b32 v57, v5, v171, v170
    v_bfi_b32 v58, v5, v170, v169
    v_bfi_b32 v59, v5, v169, v168
    ds_write_b128 v6, v[32:35] offset:33280
    ds_write_b128 v6, v[46:49] offset:37440
    ds_write_b128 v6, v[40:43] offset:41600
    ds_write_b128 v6, v[54:57] offset:45760
    ds_write_b128 v6, v[34:37] offset:49920
    ds_write_b128 v6, v[48:51] offset:54080
    ds_write_b128 v6, v[42:45] offset:58240
    ds_write_b128 v6, v[56:59] offset:62400
    s_nop 1
    v_mov_b32 v60, 0
    v_mov_b32 v61, 0
    v_mov_b32 v62, 0
    v_mov_b32 v63, 0
    v_and_b32 v7, 15, v0
    v_mul_u32_u24 v7, 4160, v7
    v_add_u32 v7, 4096, v7
    v_and_b32 v8, 31, v0
    v_lshlrev_b32 v8, 4, v8
    v_bfe_u32 v9, v0, 5, 1
    v_mul_u32_u24 v9, 4608, v9
    s_mov_b32 s9, 66560
    v_add3_u32 v8, v8, v9, s9
    ds_write_b128 v7, v[60:63]
    ds_write_b128 v8, v[60:63]
    s_branch K_prepdone
K_noprep:
    s_add_u32 s64, s38, 0x2800000
    s_addc_u32 s65, s39, 0
    s_mov_b32 s66, 0x14000
    s_mov_b32 s67, 0x20000
    v_and_b32 v181, 31, v0
    v_lshrrev_b32 v182, 5, v0
    v_cmp_gt_u32 s[88:89], 28, v181
    v_mul_u32_u24 v183, 896, v182
    v_lshl_add_u32 v183, v181, 4, v183
    s_mul_i32 s9, s4, 7168
    v_add_u32 v183, s9, v183
    v_cndmask_b32 v248, -1, v183, s[88:89]
    v_add_u32 v183, 448, v183
    v_cndmask_b32 v249, -1, v183, s[88:89]
    v_and_b32 v181, 63, v0
    v_and_b32 v182, 15, v181
    v_lshrrev_b32 v183, 4, v181
    s_mul_i32 s9, s7, 14336
    s_add_u32 s9, s9, 57344
    v_lshl_add_u32 v202, v181, 4, s9
    v_add_u32 v203, 57344, v202
    s_lshl_b32 s9, s8, 5
    v_add_u32 v184, s9, v182
    v_mul_u32_u24 v184, 448, v184
    v_bfe_u32 v185, v182, 1, 2
    v_lshrrev_b32 v186, 1, v183
    v_xor_b32 v186, v186, v185
    v_lshl_add_u32 v184, v186, 4, v184
    v_and_b32 v186, 1, v183
    v_lshl_add_u32 v184, v186, 3, v184
    v_xor_b32 v186, 32, v184
    s_cmp_eq_u32 s7, 1
    s_cselect_b64 vcc, -1, 0
    v_add_u32 v187, 192, v186
    v_cndmask_b32 v204, v184, v187, vcc
    v_add_u32 v187, 256, v184
    v_cndmask_b32 v218, v186, v187, vcc
    v_mul_u32_u24 v184, 448, v182
    v_xor_b32 v185, v185, v183
    v_lshl_add_u32 v205, v185, 4, v184
    v_subrev_u32 v219, 28672, v202
    v_lshlrev_b32 v206, 4, v181
    v_mul_u32_u24 v184, 896, v182
    s_lshl_b32 s9, s3, 6
    v_lshl_add_u32 v185, v183, 4, v184
    v_add_u32 v207, s9, v185
    s_add_u32 s9, s7, 12
    s_lshl_b32 s9, s9, 6
    s_lshl_b32 s10, s8, 5
    s_add_u32 s9, s9, s10
    v_lshl_add_u32 v185, v183, 3, v184
    v_add_u32 v208, s9, v185
    v_and_b32 v181, 63, v0
    v_lshrrev_b32 v182, 5, v181
    v_and_b32 v183, 31, v181
    v_add_u32 v184, 0, v182
    v_xor_b32 v185, v183, v184
    v_mul_u32_u24 v184, 896, v184
    v_lshl_add_u32 v200, v185, 4, v184
    v_add_u32 v184, 2, v182
    v_xor_b32 v185, v183, v184
    v_mul_u32_u24 v184, 896, v184
    v_lshl_add_u32 v201, v185, 4, v184
    v_add_u32 v184, 4, v182
    v_xor_b32 v185, v183, v184
    v_mul_u32_u24 v184, 896, v184
    v_lshl_add_u32 v209, v185, 4, v184
    v_add_u32 v184, 6, v182
    v_xor_b32 v185, v183, v184
    v_mul_u32_u24 v184, 896, v184
    v_lshl_add_u32 v210, v185, 4, v184
    v_add_u32 v184, 8, v182
    v_xor_b32 v185, v183, v184
    v_mul_u32_u24 v184, 896, v184
    v_lshl_add_u32 v211, v185, 4, v184
    v_add_u32 v184, 10, v182
    v_xor_b32 v185, v183, v184
    v_mul_u32_u24 v184, 896, v184
    v_lshl_add_u32 v212, v185, 4, v184
    v_add_u32 v184, 12, v182
    v_xor_b32 v185, v183, v184
    v_mul_u32_u24 v184, 896, v184
    v_lshl_add_u32 v213, v185, 4, v184
    v_add_u32 v184, 14, v182
    v_xor_b32 v185, v183, v184
    v_mul_u32_u24 v184, 896, v184
    v_lshl_add_u32 v214, v185, 4, v184
    v_add_u32 v184, 0, v181
    v_mul_u32_u24 v185, 2731, v184
    v_lshrrev_b32 v185, 16, v185
    v_mul_u32_u24 v186, 24, v185
    v_sub_u32 v186, v184, v186
    v_and_b32 v184, 6, v185
    v_xor_b32 v186, v186, v184
    v_mul_u32_u24 v185, 896, v185
    v_lshl_add_u32 v185, v186, 4, v185
    v_add_u32 v215, 512, v185
    v_add_u32 v184, 64, v181
    v_mul_u32_u24 v185, 2731, v184
    v_lshrrev_b32 v185, 16, v185
    v_mul_u32_u24 v186, 24, v185
    v_sub_u32 v186, v184, v186
    v_and_b32 v184, 6, v185
    v_xor_b32 v186, v186, v184
    v_mul_u32_u24 v185, 896, v185
    v_lshl_add_u32 v185, v186, 4, v185
    v_add_u32 v216, 512, v185
    v_add_u32 v184, 128, v181
    v_mul_u32_u24 v185, 2731, v184
    v_lshrrev_b32 v185, 16, v185
    v_mul_u32_u24 v186, 24, v185
    v_sub_u32 v186, v184, v186
    v_and_b32 v184, 6, v185
    v_xor_b32 v186, v186, v184
    v_mul_u32_u24 v185, 896, v185
    v_lshl_add_u32 v185, v186, 4, v185
    v_add_u32 v217, 512, v185
    v_add_u32 v184, 192, v181
    v_mul_u32_u24 v185, 2731, v184
    v_lshrrev_b32 v185, 16, v185
    v_mul_u32_u24 v186, 24, v185
    v_sub_u32 v186, v184, v186
    v_and_b32 v184, 6, v185
    v_xor_b32 v186, v186, v184
    v_mul_u32_u24 v185, 896, v185
    v_lshl_add_u32 v185, v186, 4, v185
    v_add_u32 v220, 512, v185
    v_add_u32 v184, 256, v181
    v_mul_u32_u24 v185, 2731, v184
    v_lshrrev_b32 v185, 16, v185
    v_mul_u32_u24 v186, 24, v185
    v_sub_u32 v186, v184, v186
    v_and_b32 v184, 6, v185
    v_xor_b32 v186, v186, v184
    v_mul_u32_u24 v185, 896, v185
    v_lshl_add_u32 v185, v186, 4, v185
    v_add_u32 v221, 512, v185
    v_add_u32 v184, 320, v181
    v_mul_u32_u24 v185, 2731, v184
    v_lshrrev_b32 v185, 16, v185
    v_mul_u32_u24 v186, 24, v185
    v_sub_u32 v186, v184, v186
    v_and_b32 v184, 6, v185
    v_xor_b32 v186, v186, v184
    v_mul_u32_u24 v185, 896, v185
    v_lshl_add_u32 v185, v186, 4, v185
    v_add_u32 v222, 512, v185
    s_mov_b32 s60, s16
    s_mov_b32 s61, s17
    s_mov_b32 s62, 0x1c0000
    s_mov_b32 s63, 0x20000
    buffer_load_dwordx4 v[224:227], v248, s[60:63], 0 offen
    buffer_load_dwordx4 v[228:231], v249, s[60:63], 0 offen
    s_mov_b32 s60, s36
    s_mov_b32 s61, s37
    s_mov_b32 s62, 0x100
    s_mov_b32 s63, 0x20000
    s_mov_b32 s90, 0
non_11:
    v_mov_b32 v1, 0
    buffer_load_dwordx2 v[2:3], v1, s[60:63], 0 offen sc1
    s_waitcnt vmcnt(0)
    v_readfirstlane_b32 s10, v2
    v_readfirstlane_b32 s11, v3
    s_nop 3
    s_sub_u32 s9, s10, s84
    s_subb_u32 s9, s11, s85
    s_cbranch_scc1 stale_12
    s_mov_b64 s[84:85], s[10:11]
    s_branch haven_10
stale_12:
    s_add_u32 s90, s90, 1
    s_sleep 1
    s_cmp_lt_u32 s90, 0x40000
    s_cbranch_scc1 non_11
    s_mov_b64 s[84:85], s[10:11]
haven_10:
    s_barrier
K_prepdone:
    s_cmp_eq_u32 s3, 0
    s_cbranch_scc0 xp_13
    s_getreg_b32 s9, hwreg(HW_REG_XCC_ID, 0, 4)
    s_add_u32 s9, s9, s84
    v_mov_b32 v2, s9
    v_mov_b32 v3, s85
    s_lshl_b32 s9, s4, 3
    s_add_u32 s9, s9, 6144
    v_mov_b32 v1, s9
    s_mov_b64 exec, 1
    buffer_store_dwordx2 v[2:3], v1, s[64:67], 0 offen sc1
    s_mov_b64 exec, -1
xp_13:
    s_mul_i32 s9, s6, 200704
    s_add_u32 s9, s9, 0x800000
    s_add_u32 s68, s38, s9
    s_addc_u32 s69, s39, 0
    s_mov_b32 s70, 200704
    s_mov_b32 s71, 0x20000
    s_mul_i32 s9, s5, 57344
    s_add_u32 s9, s9, 0x0
    s_add_u32 s72, s38, s9
    s_addc_u32 s73, s39, 0
    s_mov_b32 s74, 57344
    s_mov_b32 s75, 0x20000
    s_mul_i32 s9, s4, 57344
    s_add_u32 s9, s9, 0xc00000
    s_add_u32 s76, s38, s9
    s_addc_u32 s77, s39, 0
    s_mov_b32 s78, 57344
    s_mov_b32 s79, 0x20000
    s_mul_i32 s9, s5, 458752
    s_add_u32 s9, s9, 0xc00000
    s_add_u32 s80, s38, s9
    s_addc_u32 s81, s39, 0
    s_mov_b32 s82, 458752
    s_mov_b32 s83, 0x20000
    v_and_b32 v1, 63, v0
    s_lshr_b32 s9, s2, 5
    s_min_u32 s9, s9, 6
    v_mul_u32_u24 v8, 7, v1
    v_add_u32 v8, s9, v8
    s_mul_i32 s9, s6, 14
    v_subrev_u32 v9, 32, v1
    v_add_u32 v9, s9, v9
    v_add_u32 v10, 98, v9
    v_cmp_gt_u32 vcc, 46, v1
    s_nop 1
    v_cndmask_b32 v9, v10, v9, vcc
    v_cmp_gt_u32 vcc, 32, v1
    s_nop 1
    v_cndmask_b32 v8, v9, v8, vcc
    v_lshlrev_b32 v8, 3, v8
    s_and_b32 s9, s2, 7
    s_lshl_b32 s9, s9, 11
    s_add_u32 s9, s9, 16384
    v_add_u32 v8, s9, v8
    s_waitcnt lgkmcnt(0)
    s_cmp_eq_u32 s3, 0
    s_cbranch_scc0 polls_16
    s_mov_b32 s90, 0
poll_14:
    s_mov_b32 exec_lo, -1
    s_mov_b32 exec_hi, 0xfffffff
    buffer_load_dwordx2 v[2:3], v8, s[64:67], 0 offen sc1
    s_waitcnt vmcnt(0)
    s_mov_b32 s9, 1
    s_mov_b32 exec_lo, -1
    s_mov_b32 exec_hi, 0xfffffff
    v_cmp_eq_u64 vcc, s[84:85], v[2:3]
    s_nop 4
    s_cmp_eq_u64 vcc, exec
    s_cselect_b32 s9, s9, 0
    s_mov_b64 exec, -1
    s_cmp_eq_u32 s9, 1
    s_cbranch_scc1 polld_15
    s_add_u32 s90, s90, 1
    s_cmp_lt_u32 s90, 0x100000
    s_cbranch_scc0 polld_15
    s_sleep 1
    s_branch poll_14
polld_15:
polls_16:
    s_barrier
    s_lshl_b32 s9, s6, 2
    s_add_u32 s9, s9, s3
    s_mul_i32 s9, s9, 50176
    s_add_u32 s9, s9, 0xa00000
    s_add_u32 s56, s38, s9
    s_addc_u32 s57, s39, 0
    s_mov_b32 s58, 50176
    s_mov_b32 s59, 0x20000
    s_add_u32 s52, s38, 0x200000
    s_addc_u32 s53, s39, 0
    s_mov_b32 s54, 0x1c0000
    s_mov_b32 s55, 0x20000
    s_cmp_ge_u32 s2, 224
    s_cbranch_scc1 K_noconv
    s_lshl_b32 s9, s2, 13
    s_add_u32 s40, s38, s9
    s_addc_u32 s41, s39, 0
    s_mov_b32 s42, 8192
    s_mov_b32 s43, 0x20000
    v_lshlrev_b32 v10, 4, v0
    buffer_load_dwordx4 v[64:67], v10, s[40:43], 0 offen sc1
    v_add_u32 v11, 4096, v10
    buffer_load_dwordx4 v[68:71], v11, s[40:43], 0 offen sc1
    s_lshl_b32 s9, s2, 2
    s_load_dword s13, s[26:27], s9
    s_mov_b32 s15, 0
    buffer_load_dwordx4 a[0:3], v206, s[56:59], s15 offen offset:0 sc1
    buffer_load_dwordx4 a[4:7], v206, s[56:59], s15 offen offset:1024 sc1
    buffer_load_dwordx4 a[8:11], v206, s[56:59], s15 offen offset:2048 sc1
    buffer_load_dwordx4 a[12:15], v206, s[56:59], s15 offen offset:3072 sc1
    s_mov_b32 s15, 4096
    buffer_load_dwordx4 a[16:19], v206, s[56:59], s15 offen offset:0 sc1
    buffer_load_dwordx4 a[20:23], v206, s[56:59], s15 offen offset:1024 sc1
    buffer_load_dwordx4 a[24:27], v206, s[56:59], s15 offen offset:2048 sc1
    buffer_load_dwordx4 a[28:31], v206, s[56:59], s15 offen offset:3072 sc1
    s_mov_b32 s15, 8192
    buffer_load_dwordx4 a[32:35], v206, s[56:59], s15 offen offset:0 sc1
    buffer_load_dwordx4 a[36:39], v206, s[56:59], s15 offen offset:1024 sc1
    buffer_load_dwordx4 a[40:43], v206, s[56:59], s15 offen offset:2048 sc1
    buffer_load_dwordx4 a[44:47], v206, s[56:59], s15 offen offset:3072 sc1
    v_add_u32 v10, 67072, v10
    s_waitcnt vmcnt(12)
    ds_write_b128 v10, v[64:67]
    ds_write_b128 v10, v[68:71] offset:4608
    s_waitcnt lgkmcnt(0)
    s_lshl_b32 s12, s13, 16
    s_and_b32 s14, s13, 0xffff0000
    s_cmp_eq_u32 s8, 0
    s_cselect_b32 s14, s12, s14
    s_barrier
    v_and_b32 v1, 63, v0
    v_and_b32 v2, 15, v1
    v_lshrrev_b32 v3, 4, v1
    v_and_b32 v4, 7, v2
    v_sub_u32 v4, 7, v4
    v_mul_u32_u24 v4, 4160, v4
    v_lshrrev_b32 v5, 3, v2
    v_sub_u32 v5, v3, v5
    v_add_u32 v5, 1, v5
    v_lshl_add_u32 v4, v5, 4, v4
    s_mul_i32 s9, s8, 33280
    v_add_u32 v12, s9, v4
    s_mul_i32 s9, s8, 4608
    s_add_u32 s9, s9, 66592
    v_lshlrev_b32 v5, 5, v2
    v_lshl_add_u32 v5, v3, 4, v5
    v_add_u32 v13, s9, v5
    s_cmp_eq_u32 s7, 1
    s_cbranch_scc1 cset1_17
    ds_read_b128 v[96:99], v12 offset:4032
    ds_read_b128 v[16:19], v13 offset:448
    ds_read_b128 v[100:103], v12 offset:3520
    ds_read_b128 v[20:23], v13 offset:960
    ds_read_b128 v[104:107], v12 offset:3008
    ds_read_b128 v[24:27], v13 offset:1472
    ds_read_b128 v[108:111], v12 offset:2496
    ds_read_b128 v[28:31], v13 offset:1984
    ds_read_b128 v[112:115], v12 offset:1984
    ds_read_b128 v[32:35], v13 offset:2496
    ds_read_b128 v[116:119], v12 offset:1472
    ds_read_b128 v[36:39], v13 offset:3008
    ds_read_b128 v[120:123], v12 offset:960
    ds_read_b128 v[40:43], v13 offset:3520
    ds_read_b128 v[124:127], v12 offset:448
    ds_read_b128 v[160:163], v13 offset:4032
    s_waitcnt lgkmcnt(14)
    v_mfma_f32_16x16x32_bf16 v[72:75], v[96:99], v[16:19], 0
    ds_read_b128 v[128:131], v12 offset:3968
    s_waitcnt lgkmcnt(11)
    v_mfma_f32_16x16x32_bf16 v[76:79], v[100:103], v[24:27], 0
    ds_read_b128 v[44:47], v13 offset:384
    v_mfma_f32_16x16x32_bf16 v[76:79], v[104:107], v[20:23], v[76:79]
    ds_read_b128 v[132:135], v12 offset:3456
    v_mfma_f32_16x16x32_bf16 v[80:83], v[104:107], v[24:27], 0
    ds_read_b128 v[48:51], v13 offset:896
    s_mov_b32 s15, 12288
    buffer_load_dwordx4 a[48:51], v206, s[56:59], s15 offen offset:0 sc1
    s_waitcnt lgkmcnt(12)
    v_mfma_f32_16x16x32_bf16 v[76:79], v[96:99], v[28:31], v[76:79]
    ds_read_b128 v[136:139], v12 offset:2944
    v_mfma_f32_16x16x32_bf16 v[76:79], v[108:111], v[16:19], v[76:79]
    ds_read_b128 v[52:55], v13 offset:1408
    v_mfma_f32_16x16x32_bf16 v[80:83], v[100:103], v[28:31], v[80:83]
    ds_read_b128 v[140:143], v12 offset:2432
    buffer_load_dwordx4 a[52:55], v206, s[56:59], s15 offen offset:1024 sc1
    v_mfma_f32_16x16x32_bf16 v[80:83], v[108:111], v[20:23], v[80:83]
    ds_read_b128 v[56:59], v13 offset:1920
    s_waitcnt lgkmcnt(14)
    v_mfma_f32_16x16x32_bf16 v[80:83], v[96:99], v[32:35], v[80:83]
    ds_read_b128 v[144:147], v12 offset:1920
    v_mfma_f32_16x16x32_bf16 v[80:83], v[112:115], v[16:19], v[80:83]
    ds_read_b128 v[60:63], v13 offset:2432
    buffer_load_dwordx4 a[56:59], v206, s[56:59], s15 offen offset:2048 sc1
    v_mfma_f32_16x16x32_bf16 v[84:87], v[108:111], v[32:35], 0
    ds_read_b128 v[148:151], v12 offset:1408
    v_mfma_f32_16x16x32_bf16 v[84:87], v[112:115], v[28:31], v[84:87]
    ds_read_b128 v[64:67], v13 offset:2944
    s_waitcnt lgkmcnt(15)
    v_mfma_f32_16x16x32_bf16 v[84:87], v[104:107], v[36:39], v[84:87]
    ds_read_b128 v[152:155], v12 offset:896
    buffer_load_dwordx4 a[60:63], v206, s[56:59], s15 offen offset:3072 sc1
    v_mfma_f32_16x16x32_bf16 v[84:87], v[116:119], v[24:27], v[84:87]
    ds_read_b128 v[68:71], v13 offset:3456
    s_waitcnt lgkmcnt(15)
    v_mfma_f32_16x16x32_bf16 v[84:87], v[100:103], v[40:43], v[84:87]
    ds_read_b128 v[156:159], v12 offset:384
    v_mfma_f32_16x16x32_bf16 v[84:87], v[120:123], v[20:23], v[84:87]
    ds_read_b128 v[164:167], v13 offset:3968
    s_mov_b32 s15, 16384
    buffer_load_dwordx4 a[64:67], v206, s[56:59], s15 offen offset:0 sc1
    s_waitcnt lgkmcnt(15)
    v_mfma_f32_16x16x32_bf16 v[84:87], v[96:99], v[160:163], v[84:87]
    v_mfma_f32_16x16x32_bf16 v[84:87], v[124:127], v[16:19], v[84:87]
    buffer_load_dwordx4 a[68:71], v206, s[56:59], s15 offen offset:1024 sc1
    s_waitcnt lgkmcnt(14)
    v_mfma_f32_16x16x32_bf16 v[72:75], v[128:131], v[44:47], v[72:75]
    ds_read_b128 v[96:99], v12 offset:3904
    s_waitcnt lgkmcnt(11)
    v_mfma_f32_16x16x32_bf16 v[76:79], v[132:135], v[52:55], v[76:79]
    ds_read_b128 v[16:19], v13 offset:320
    v_mfma_f32_16x16x32_bf16 v[76:79], v[136:139], v[48:51], v[76:79]
    ds_read_b128 v[100:103], v12 offset:3392
    v_mfma_f32_16x16x32_bf16 v[80:83], v[136:139], v[52:55], v[80:83]
    ds_read_b128 v[20:23], v13 offset:832
    buffer_load_dwordx4 a[72:75], v206, s[56:59], s15 offen offset:2048 sc1
    s_waitcnt lgkmcnt(12)
    v_mfma_f32_16x16x32_bf16 v[76:79], v[128:131], v[56:59], v[76:79]
    ds_read_b128 v[104:107], v12 offset:2880
    v_mfma_f32_16x16x32_bf16 v[76:79], v[140:143], v[44:47], v[76:79]
    ds_read_b128 v[24:27], v13 offset:1344
    v_mfma_f32_16x16x32_bf16 v[80:83], v[132:135], v[56:59], v[80:83]
    ds_read_b128 v[108:111], v12 offset:2368
    buffer_load_dwordx4 a[76:79], v206, s[56:59], s15 offen offset:3072 sc1
    v_mfma_f32_16x16x32_bf16 v[80:83], v[140:143], v[48:51], v[80:83]
    ds_read_b128 v[28:31], v13 offset:1856
    s_waitcnt lgkmcnt(14)
    v_mfma_f32_16x16x32_bf16 v[80:83], v[128:131], v[60:63], v[80:83]
    ds_read_b128 v[112:115], v12 offset:1856
    v_mfma_f32_16x16x32_bf16 v[80:83], v[144:147], v[44:47], v[80:83]
    ds_read_b128 v[32:35], v13 offset:2368
    s_mov_b32 s15, 20480
    buffer_load_dwordx4 a[80:83], v206, s[56:59], s15 offen offset:0 sc1
    v_mfma_f32_16x16x32_bf16 v[84:87], v[140:143], v[60:63], v[84:87]
    ds_read_b128 v[116:119], v12 offset:1344
    v_mfma_f32_16x16x32_bf16 v[84:87], v[144:147], v[56:59], v[84:87]
    ds_read_b128 v[36:39], v13 offset:2880
    s_waitcnt lgkmcnt(15)
    v_mfma_f32_16x16x32_bf16 v[84:87], v[136:139], v[64:67], v[84:87]
    ds_read_b128 v[120:123], v12 offset:832
    buffer_load_dwordx4 a[84:87], v206, s[56:59], s15 offen offset:1024 sc1
    v_mfma_f32_16x16x32_bf16 v[84:87], v[148:151], v[52:55], v[84:87]
    ds_read_b128 v[40:43], v13 offset:3392
    s_waitcnt lgkmcnt(15)
    v_mfma_f32_16x16x32_bf16 v[84:87], v[132:135], v[68:71], v[84:87]
    ds_read_b128 v[124:127], v12 offset:320
    v_mfma_f32_16x16x32_bf16 v[84:87], v[152:155], v[48:51], v[84:87]
    ds_read_b128 v[160:163], v13 offset:3904
    buffer_load_dwordx4 a[88:91], v206, s[56:59], s15 offen offset:2048 sc1
    s_waitcnt lgkmcnt(15)
    v_mfma_f32_16x16x32_bf16 v[84:87], v[128:131], v[164:167], v[84:87]
    v_mfma_f32_16x16x32_bf16 v[84:87], v[156:159], v[44:47], v[84:87]
    buffer_load_dwordx4 a[92:95], v206, s[56:59], s15 offen offset:3072 sc1
    s_waitcnt lgkmcnt(14)
    v_mfma_f32_16x16x32_bf16 v[72:75], v[96:99], v[16:19], v[72:75]
    ds_read_b128 v[128:131], v12 offset:3840
    s_waitcnt lgkmcnt(11)
    v_mfma_f32_16x16x32_bf16 v[76:79], v[100:103], v[24:27], v[76:79]
    ds_read_b128 v[44:47], v13 offset:256
    v_mfma_f32_16x16x32_bf16 v[76:79], v[104:107], v[20:23], v[76:79]
    ds_read_b128 v[132:135], v12 offset:3328
    v_mfma_f32_16x16x32_bf16 v[80:83], v[104:107], v[24:27], v[80:83]
    ds_read_b128 v[48:51], v13 offset:768
    s_mov_b32 s15, 24576
    buffer_load_dwordx4 a[96:99], v206, s[56:59], s15 offen offset:0 sc1
    s_waitcnt lgkmcnt(12)
    v_mfma_f32_16x16x32_bf16 v[76:79], v[96:99], v[28:31], v[76:79]
    ds_read_b128 v[136:139], v12 offset:2816
    v_mfma_f32_16x16x32_bf16 v[76:79], v[108:111], v[16:19], v[76:79]
    ds_read_b128 v[52:55], v13 offset:1280
    v_mfma_f32_16x16x32_bf16 v[80:83], v[100:103], v[28:31], v[80:83]
    ds_read_b128 v[140:143], v12 offset:2304
    buffer_load_dwordx4 a[100:103], v206, s[56:59], s15 offen offset:1024 sc1
    v_mfma_f32_16x16x32_bf16 v[80:83], v[108:111], v[20:23], v[80:83]
    ds_read_b128 v[56:59], v13 offset:1792
    s_waitcnt lgkmcnt(14)
    v_mfma_f32_16x16x32_bf16 v[80:83], v[96:99], v[32:35], v[80:83]
    ds_read_b128 v[144:147], v12 offset:1792
    v_mfma_f32_16x16x32_bf16 v[80:83], v[112:115], v[16:19], v[80:83]
    ds_read_b128 v[60:63], v13 offset:2304
    buffer_load_dwordx4 a[104:107], v206, s[56:59], s15 offen offset:2048 sc1
    v_mfma_f32_16x16x32_bf16 v[84:87], v[108:111], v[32:35], v[84:87]
    ds_read_b128 v[148:151], v12 offset:1280
    v_mfma_f32_16x16x32_bf16 v[84:87], v[112:115], v[28:31], v[84:87]
    ds_read_b128 v[64:67], v13 offset:2816
    s_waitcnt lgkmcnt(15)
    v_mfma_f32_16x16x32_bf16 v[84:87], v[104:107], v[36:39], v[84:87]
    ds_read_b128 v[152:155], v12 offset:768
    buffer_load_dwordx4 a[108:111], v206, s[56:59], s15 offen offset:3072 sc1
    v_mfma_f32_16x16x32_bf16 v[84:87], v[116:119], v[24:27], v[84:87]
    ds_read_b128 v[68:71], v13 offset:3328
    s_waitcnt lgkmcnt(15)
    v_mfma_f32_16x16x32_bf16 v[84:87], v[100:103], v[40:43], v[84:87]
    ds_read_b128 v[156:159], v12 offset:256
    v_mfma_f32_16x16x32_bf16 v[84:87], v[120:123], v[20:23], v[84:87]
    ds_read_b128 v[164:167], v13 offset:3840
    s_mov_b32 s15, 28672
    buffer_load_dwordx4 a[112:115], v206, s[56:59], s15 offen offset:0 sc1
    s_waitcnt lgkmcnt(15)
    v_mfma_f32_16x16x32_bf16 v[84:87], v[96:99], v[160:163], v[84:87]
    v_mfma_f32_16x16x32_bf16 v[84:87], v[124:127], v[16:19], v[84:87]
    buffer_load_dwordx4 a[116:119], v206, s[56:59], s15 offen offset:1024 sc1
    s_waitcnt lgkmcnt(14)
    v_mfma_f32_16x16x32_bf16 v[72:75], v[128:131], v[44:47], v[72:75]
    ds_read_b128 v[96:99], v12 offset:3776
    s_waitcnt lgkmcnt(11)
    v_mfma_f32_16x16x32_bf16 v[76:79], v[132:135], v[52:55], v[76:79]
    ds_read_b128 v[16:19], v13 offset:192
    v_mfma_f32_16x16x32_bf16 v[76:79], v[136:139], v[48:51], v[76:79]
    ds_read_b128 v[100:103], v12 offset:3264
    v_mfma_f32_16x16x32_bf16 v[80:83], v[136:139], v[52:55], v[80:83]
    ds_read_b128 v[20:23], v13 offset:704
    buffer_load_dwordx4 a[120:123], v206, s[56:59], s15 offen offset:2048 sc1
    s_waitcnt lgkmcnt(12)
    v_mfma_f32_16x16x32_bf16 v[76:79], v[128:131], v[56:59], v[76:79]
    ds_read_b128 v[104:107], v12 offset:2752
    v_mfma_f32_16x16x32_bf16 v[76:79], v[140:143], v[44:47], v[76:79]
    ds_read_b128 v[24:27], v13 offset:1216
    v_mfma_f32_16x16x32_bf16 v[80:83], v[132:135], v[56:59], v[80:83]
    ds_read_b128 v[108:111], v12 offset:2240
    buffer_load_dwordx4 a[124:127], v206, s[56:59], s15 offen offset:3072 sc1
    v_mfma_f32_16x16x32_bf16 v[80:83], v[140:143], v[48:51], v[80:83]
    ds_read_b128 v[28:31], v13 offset:1728
    s_waitcnt lgkmcnt(14)
    v_mfma_f32_16x16x32_bf16 v[80:83], v[128:131], v[60:63], v[80:83]
    ds_read_b128 v[112:115], v12 offset:1728
    v_mfma_f32_16x16x32_bf16 v[80:83], v[144:147], v[44:47], v[80:83]
    ds_read_b128 v[32:35], v13 offset:2240
    s_mov_b32 s15, 32768
    buffer_load_dwordx4 a[128:131], v206, s[56:59], s15 offen offset:0 sc1
    v_mfma_f32_16x16x32_bf16 v[84:87], v[140:143], v[60:63], v[84:87]
    ds_read_b128 v[116:119], v12 offset:1216
    v_mfma_f32_16x16x32_bf16 v[84:87], v[144:147], v[56:59], v[84:87]
    ds_read_b128 v[36:39], v13 offset:2752
    s_waitcnt lgkmcnt(15)
    v_mfma_f32_16x16x32_bf16 v[84:87], v[136:139], v[64:67], v[84:87]
    ds_read_b128 v[120:123], v12 offset:704
    buffer_load_dwordx4 a[132:135], v206, s[56:59], s15 offen offset:1024 sc1
    v_mfma_f32_16x16x32_bf16 v[84:87], v[148:151], v[52:55], v[84:87]
    ds_read_b128 v[40:43], v13 offset:3264
    s_waitcnt lgkmcnt(15)
    v_mfma_f32_16x16x32_bf16 v[84:87], v[132:135], v[68:71], v[84:87]
    ds_read_b128 v[124:127], v12 offset:192
    v_mfma_f32_16x16x32_bf16 v[84:87], v[152:155], v[48:51], v[84:87]
    ds_read_b128 v[160:163], v13 offset:3776
    buffer_load_dwordx4 a[136:139], v206, s[56:59], s15 offen offset:2048 sc1
    s_waitcnt lgkmcnt(15)
    v_mfma_f32_16x16x32_bf16 v[84:87], v[128:131], v[164:167], v[84:87]
    v_mfma_f32_16x16x32_bf16 v[84:87], v[156:159], v[44:47], v[84:87]
    buffer_load_dwordx4 a[140:143], v206, s[56:59], s15 offen offset:3072 sc1
    s_waitcnt lgkmcnt(14)
    v_mfma_f32_16x16x32_bf16 v[72:75], v[96:99], v[16:19], v[72:75]
    ds_read_b128 v[128:131], v12 offset:3712
    s_waitcnt lgkmcnt(11)
    v_mfma_f32_16x16x32_bf16 v[76:79], v[100:103], v[24:27], v[76:79]
    ds_read_b128 v[44:47], v13 offset:128
    v_mfma_f32_16x16x32_bf16 v[76:79], v[104:107], v[20:23], v[76:79]
    ds_read_b128 v[132:135], v12 offset:3200
    v_mfma_f32_16x16x32_bf16 v[80:83], v[104:107], v[24:27], v[80:83]
    ds_read_b128 v[48:51], v13 offset:640
    s_mov_b32 s15, 36864
    buffer_load_dwordx4 a[144:147], v206, s[56:59], s15 offen offset:0 sc1
    s_waitcnt lgkmcnt(12)
    v_mfma_f32_16x16x32_bf16 v[76:79], v[96:99], v[28:31], v[76:79]
    ds_read_b128 v[136:139], v12 offset:2688
    v_mfma_f32_16x16x32_bf16 v[76:79], v[108:111], v[16:19], v[76:79]
    ds_read_b128 v[52:55], v13 offset:1152
    v_mfma_f32_16x16x32_bf16 v[80:83], v[100:103], v[28:31], v[80:83]
    ds_read_b128 v[140:143], v12 offset:2176
    buffer_load_dwordx4 a[148:151], v206, s[56:59], s15 offen offset:1024 sc1
    v_mfma_f32_16x16x32_bf16 v[80:83], v[108:111], v[20:23], v[80:83]
    ds_read_b128 v[56:59], v13 offset:1664
    s_waitcnt lgkmcnt(14)
    v_mfma_f32_16x16x32_bf16 v[80:83], v[96:99], v[32:35], v[80:83]
    ds_read_b128 v[144:147], v12 offset:1664
    v_mfma_f32_16x16x32_bf16 v[80:83], v[112:115], v[16:19], v[80:83]
    ds_read_b128 v[60:63], v13 offset:2176
    buffer_load_dwordx4 a[152:155], v206, s[56:59], s15 offen offset:2048 sc1
    v_mfma_f32_16x16x32_bf16 v[84:87], v[108:111], v[32:35], v[84:87]
    ds_read_b128 v[148:151], v12 offset:1152
    v_mfma_f32_16x16x32_bf16 v[84:87], v[112:115], v[28:31], v[84:87]
    ds_read_b128 v[64:67], v13 offset:2688
    s_waitcnt lgkmcnt(15)
    v_mfma_f32_16x16x32_bf16 v[84:87], v[104:107], v[36:39], v[84:87]
    ds_read_b128 v[152:155], v12 offset:640
    buffer_load_dwordx4 a[156:159], v206, s[56:59], s15 offen offset:3072 sc1
    v_mfma_f32_16x16x32_bf16 v[84:87], v[116:119], v[24:27], v[84:87]
    ds_read_b128 v[68:71], v13 offset:3200
    s_waitcnt lgkmcnt(15)
    v_mfma_f32_16x16x32_bf16 v[84:87], v[100:103], v[40:43], v[84:87]
    ds_read_b128 v[156:159], v12 offset:128
    v_mfma_f32_16x16x32_bf16 v[84:87], v[120:123], v[20:23], v[84:87]
    ds_read_b128 v[164:167], v13 offset:3712
    s_mov_b32 s15, 40960
    buffer_load_dwordx4 a[160:163], v206, s[56:59], s15 offen offset:0 sc1
    s_waitcnt lgkmcnt(15)
    v_mfma_f32_16x16x32_bf16 v[84:87], v[96:99], v[160:163], v[84:87]
    v_mfma_f32_16x16x32_bf16 v[84:87], v[124:127], v[16:19], v[84:87]
    buffer_load_dwordx4 a[164:167], v206, s[56:59], s15 offen offset:1024 sc1
    s_waitcnt lgkmcnt(14)
    v_mfma_f32_16x16x32_bf16 v[72:75], v[128:131], v[44:47], v[72:75]
    ds_read_b128 v[96:99], v12 offset:3648
    s_waitcnt lgkmcnt(11)
    v_mfma_f32_16x16x32_bf16 v[76:79], v[132:135], v[52:55], v[76:79]
    ds_read_b128 v[16:19], v13 offset:64
    v_mfma_f32_16x16x32_bf16 v[76:79], v[136:139], v[48:51], v[76:79]
    ds_read_b128 v[100:103], v12 offset:3136
    v_mfma_f32_16x16x32_bf16 v[80:83], v[136:139], v[52:55], v[80:83]
    ds_read_b128 v[20:23], v13 offset:576
    buffer_load_dwordx4 a[168:171], v206, s[56:59], s15 offen offset:2048 sc1
    s_waitcnt lgkmcnt(12)
    v_mfma_f32_16x16x32_bf16 v[76:79], v[128:131], v[56:59], v[76:79]
    ds_read_b128 v[104:107], v12 offset:2624
    v_mfma_f32_16x16x32_bf16 v[76:79], v[140:143], v[44:47], v[76:79]
    ds_read_b128 v[24:27], v13 offset:1088
    v_mfma_f32_16x16x32_bf16 v[80:83], v[132:135], v[56:59], v[80:83]
    ds_read_b128 v[108:111], v12 offset:2112
    buffer_load_dwordx4 a[172:175], v206, s[56:59], s15 offen offset:3072 sc1
    v_mfma_f32_16x16x32_bf16 v[80:83], v[140:143], v[48:51], v[80:83]
    ds_read_b128 v[28:31], v13 offset:1600
    s_waitcnt lgkmcnt(14)
    v_mfma_f32_16x16x32_bf16 v[80:83], v[128:131], v[60:63], v[80:83]
    ds_read_b128 v[112:115], v12 offset:1600
    v_mfma_f32_16x16x32_bf16 v[80:83], v[144:147], v[44:47], v[80:83]
    ds_read_b128 v[32:35], v13 offset:2112
    s_mov_b32 s15, 45056
    buffer_load_dwordx4 a[176:179], v206, s[56:59], s15 offen offset:0 sc1
    v_mfma_f32_16x16x32_bf16 v[84:87], v[140:143], v[60:63], v[84:87]
    ds_read_b128 v[116:119], v12 offset:1088
    v_mfma_f32_16x16x32_bf16 v[84:87], v[144:147], v[56:59], v[84:87]
    ds_read_b128 v[36:39], v13 offset:2624
    s_waitcnt lgkmcnt(15)
    v_mfma_f32_16x16x32_bf16 v[84:87], v[136:139], v[64:67], v[84:87]
    ds_read_b128 v[120:123], v12 offset:576
    buffer_load_dwordx4 a[180:183], v206, s[56:59], s15 offen offset:1024 sc1
    v_mfma_f32_16x16x32_bf16 v[84:87], v[148:151], v[52:55], v[84:87]
    ds_read_b128 v[40:43], v13 offset:3136
    s_waitcnt lgkmcnt(15)
    v_mfma_f32_16x16x32_bf16 v[84:87], v[132:135], v[68:71], v[84:87]
    ds_read_b128 v[124:127], v12 offset:64
    v_mfma_f32_16x16x32_bf16 v[84:87], v[152:155], v[48:51], v[84:87]
    ds_read_b128 v[160:163], v13 offset:3648
    buffer_load_dwordx4 a[184:187], v206, s[56:59], s15 offen offset:2048 sc1
    s_waitcnt lgkmcnt(15)
    v_mfma_f32_16x16x32_bf16 v[84:87], v[128:131], v[164:167], v[84:87]
    v_mfma_f32_16x16x32_bf16 v[84:87], v[156:159], v[44:47], v[84:87]
    buffer_load_dwordx4 a[188:191], v206, s[56:59], s15 offen offset:3072 sc1
    s_waitcnt lgkmcnt(14)
    v_mfma_f32_16x16x32_bf16 v[72:75], v[96:99], v[16:19], v[72:75]
    ds_read_b128 v[128:131], v12 offset:3584
    s_waitcnt lgkmcnt(11)
    v_mfma_f32_16x16x32_bf16 v[76:79], v[100:103], v[24:27], v[76:79]
    ds_read_b128 v[44:47], v13 offset:0
    v_mfma_f32_16x16x32_bf16 v[76:79], v[104:107], v[20:23], v[76:79]
    ds_read_b128 v[132:135], v12 offset:3072
    v_mfma_f32_16x16x32_bf16 v[80:83], v[104:107], v[24:27], v[80:83]
    ds_read_b128 v[48:51], v13 offset:512
    s_mov_b32 s15, 49152
    buffer_load_dwordx4 a[192:195], v206, s[56:59], s15 offen offset:0 sc1
    s_waitcnt lgkmcnt(12)
    v_mfma_f32_16x16x32_bf16 v[76:79], v[96:99], v[28:31], v[76:79]
    ds_read_b128 v[136:139], v12 offset:2560
    v_mfma_f32_16x16x32_bf16 v[76:79], v[108:111], v[16:19], v[76:79]
    ds_read_b128 v[52:55], v13 offset:1024
    v_mfma_f32_16x16x32_bf16 v[80:83], v[100:103], v[28:31], v[80:83]
    ds_read_b128 v[140:143], v12 offset:2048
    v_mfma_f32_16x16x32_bf16 v[80:83], v[108:111], v[20:23], v[80:83]
    ds_read_b128 v[56:59], v13 offset:1536
    s_waitcnt lgkmcnt(14)
    v_mfma_f32_16x16x32_bf16 v[80:83], v[96:99], v[32:35], v[80:83]
    ds_read_b128 v[144:147], v12 offset:1536
    v_mfma_f32_16x16x32_bf16 v[80:83], v[112:115], v[16:19], v[80:83]
    ds_read_b128 v[60:63], v13 offset:2048
    v_mfma_f32_16x16x32_bf16 v[84:87], v[108:111], v[32:35], v[84:87]
    ds_read_b128 v[148:151], v12 offset:1024
    v_mfma_f32_16x16x32_bf16 v[84:87], v[112:115], v[28:31], v[84:87]
    ds_read_b128 v[64:67], v13 offset:2560
    s_waitcnt lgkmcnt(15)
    v_mfma_f32_16x16x32_bf16 v[84:87], v[104:107], v[36:39], v[84:87]
    ds_read_b128 v[152:155], v12 offset:512
    v_mfma_f32_16x16x32_bf16 v[84:87], v[116:119], v[24:27], v[84:87]
    ds_read_b128 v[68:71], v13 offset:3072
    s_waitcnt lgkmcnt(15)
    v_mfma_f32_16x16x32_bf16 v[84:87], v[100:103], v[40:43], v[84:87]
    ds_read_b128 v[156:159], v12 offset:0
    v_mfma_f32_16x16x32_bf16 v[84:87], v[120:123], v[20:23], v[84:87]
    ds_read_b128 v[164:167], v13 offset:3584
    s_waitcnt lgkmcnt(15)
    v_mfma_f32_16x16x32_bf16 v[84:87], v[96:99], v[160:163], v[84:87]
    v_mfma_f32_16x16x32_bf16 v[84:87], v[124:127], v[16:19], v[84:87]
    s_waitcnt lgkmcnt(14)
    v_mfma_f32_16x16x32_bf16 v[72:75], v[128:131], v[44:47], v[72:75]
    s_waitcnt lgkmcnt(10)
    v_mfma_f32_16x16x32_bf16 v[76:79], v[132:135], v[52:55], v[76:79]
    v_mfma_f32_16x16x32_bf16 v[76:79], v[136:139], v[48:51], v[76:79]
    v_mfma_f32_16x16x32_bf16 v[80:83], v[136:139], v[52:55], v[80:83]
    s_waitcnt lgkmcnt(8)
    v_mfma_f32_16x16x32_bf16 v[76:79], v[128:131], v[56:59], v[76:79]
    v_mfma_f32_16x16x32_bf16 v[76:79], v[140:143], v[44:47], v[76:79]
    v_mfma_f32_16x16x32_bf16 v[80:83], v[132:135], v[56:59], v[80:83]
    v_mfma_f32_16x16x32_bf16 v[80:83], v[140:143], v[48:51], v[80:83]
    s_waitcnt lgkmcnt(6)
    v_mfma_f32_16x16x32_bf16 v[80:83], v[128:131], v[60:63], v[80:83]
    v_mfma_f32_16x16x32_bf16 v[80:83], v[144:147], v[44:47], v[80:83]
    v_mfma_f32_16x16x32_bf16 v[84:87], v[140:143], v[60:63], v[84:87]
    v_mfma_f32_16x16x32_bf16 v[84:87], v[144:147], v[56:59], v[84:87]
    s_waitcnt lgkmcnt(4)
    v_mfma_f32_16x16x32_bf16 v[84:87], v[136:139], v[64:67], v[84:87]
    v_mfma_f32_16x16x32_bf16 v[84:87], v[148:151], v[52:55], v[84:87]
    s_waitcnt lgkmcnt(2)
    v_mfma_f32_16x16x32_bf16 v[84:87], v[132:135], v[68:71], v[84:87]
    v_mfma_f32_16x16x32_bf16 v[84:87], v[152:155], v[48:51], v[84:87]
    s_waitcnt lgkmcnt(0)
    v_mfma_f32_16x16x32_bf16 v[84:87], v[128:131], v[164:167], v[84:87]
    v_mfma_f32_16x16x32_bf16 v[84:87], v[156:159], v[44:47], v[84:87]
    s_barrier
    s_mul_i32 s9, s8, 4608
    s_add_u32 s9, s9, 67072
    v_lshlrev_b32 v5, 5, v2
    v_lshl_add_u32 v5, v3, 3, v5
    v_add_u32 v6, s9, v5
    s_mul_i32 s9, s8, 4224
    v_add_u32 v7, s9, v5
    ds_read_b64 v[96:97], v6 offset:0
    ds_read_b64 v[98:99], v6 offset:1536
    ds_read_b64 v[100:101], v6 offset:2048
    ds_read_b64 v[102:103], v6 offset:3584
    v_mov_b32 v8, 0xffff0000
    s_waitcnt lgkmcnt(3)
    v_lshlrev_b32 v16, 16, v96
    v_and_b32 v17, v8, v96
    v_lshlrev_b32 v18, 16, v97
    v_and_b32 v19, v8, v97
    v_fma_f32 v16, v16, s14, v72
    v_fma_f32 v17, v17, s14, v73
    v_fma_f32 v18, v18, s14, v74
    v_fma_f32 v19, v19, s14, v75
    v_cvt_pk_bf16_f32 v16, v16, v17
    v_cvt_pk_bf16_f32 v17, v18, v19
    ds_write_b64 v7, v[16:17] offset:0
    s_waitcnt lgkmcnt(3)
    v_lshlrev_b32 v20, 16, v98
    v_and_b32 v21, v8, v98
    v_lshlrev_b32 v22, 16, v99
    v_and_b32 v23, v8, v99
    v_fma_f32 v20, v20, s14, v76
    v_fma_f32 v21, v21, s14, v77
    v_fma_f32 v22, v22, s14, v78
    v_fma_f32 v23, v23, s14, v79
    v_cvt_pk_bf16_f32 v20, v20, v21
    v_cvt_pk_bf16_f32 v21, v22, v23
    ds_write_b64 v7, v[20:21] offset:1536
    s_waitcnt lgkmcnt(3)
    v_lshlrev_b32 v24, 16, v100
    v_and_b32 v25, v8, v100
    v_lshlrev_b32 v26, 16, v101
    v_and_b32 v27, v8, v101
    v_fma_f32 v24, v24, s14, v80
    v_fma_f32 v25, v25, s14, v81
    v_fma_f32 v26, v26, s14, v82
    v_fma_f32 v27, v27, s14, v83
    v_cvt_pk_bf16_f32 v24, v24, v25
    v_cvt_pk_bf16_f32 v25, v26, v27
    ds_write_b64 v7, v[24:25] offset:2048
    s_waitcnt lgkmcnt(3)
    v_lshlrev_b32 v28, 16, v102
    v_and_b32 v29, v8, v102
    v_lshlrev_b32 v30, 16, v103
    v_and_b32 v31, v8, v103
    v_fma_f32 v28, v28, s14, v84
    v_fma_f32 v29, v29, s14, v85
    v_fma_f32 v30, v30, s14, v86
    v_fma_f32 v31, v31, s14, v87
    v_cvt_pk_bf16_f32 v28, v28, v29
    v_cvt_pk_bf16_f32 v29, v30, v31
    ds_write_b64 v7, v[28:29] offset:3584
    s_waitcnt lgkmcnt(0)
    s_branch cjoin_18
cset1_17:
    ds_read_b128 v[96:99], v12 offset:4032
    ds_read_b128 v[16:19], v13 offset:448
    ds_read_b128 v[100:103], v12 offset:3520
    ds_read_b128 v[20:23], v13 offset:960
    ds_read_b128 v[104:107], v12 offset:3008
    ds_read_b128 v[24:27], v13 offset:1472
    ds_read_b128 v[108:111], v12 offset:2496
    ds_read_b128 v[28:31], v13 offset:1984
    ds_read_b128 v[112:115], v12 offset:1984
    ds_read_b128 v[32:35], v13 offset:2496
    ds_read_b128 v[116:119], v12 offset:1472
    ds_read_b128 v[36:39], v13 offset:3008
    ds_read_b128 v[120:123], v12 offset:960
    ds_read_b128 v[40:43], v13 offset:3520
    s_waitcnt lgkmcnt(10)
    v_mfma_f32_16x16x32_bf16 v[72:75], v[96:99], v[20:23], 0
    ds_read_b128 v[128:131], v12 offset:3968
    v_mfma_f32_16x16x32_bf16 v[72:75], v[100:103], v[16:19], v[72:75]
    ds_read_b128 v[44:47], v13 offset:384
    v_mfma_f32_16x16x32_bf16 v[76:79], v[100:103], v[20:23], 0
    ds_read_b128 v[132:135], v12 offset:3456
    s_waitcnt lgkmcnt(11)
    v_mfma_f32_16x16x32_bf16 v[76:79], v[96:99], v[24:27], v[76:79]
    ds_read_b128 v[48:51], v13 offset:896
    s_mov_b32 s15, 12288
    buffer_load_dwordx4 a[48:51], v206, s[56:59], s15 offen offset:0 sc1
    v_mfma_f32_16x16x32_bf16 v[76:79], v[104:107], v[16:19], v[76:79]
    ds_read_b128 v[136:139], v12 offset:2944
    s_waitcnt lgkmcnt(11)
    v_mfma_f32_16x16x32_bf16 v[80:83], v[104:107], v[28:31], 0
    ds_read_b128 v[52:55], v13 offset:1408
    v_mfma_f32_16x16x32_bf16 v[80:83], v[108:111], v[24:27], v[80:83]
    ds_read_b128 v[140:143], v12 offset:2432
    buffer_load_dwordx4 a[52:55], v206, s[56:59], s15 offen offset:1024 sc1
    v_mfma_f32_16x16x32_bf16 v[84:87], v[108:111], v[28:31], 0
    ds_read_b128 v[56:59], v13 offset:1920
    s_waitcnt lgkmcnt(12)
    v_mfma_f32_16x16x32_bf16 v[80:83], v[100:103], v[32:35], v[80:83]
    ds_read_b128 v[144:147], v12 offset:1920
    v_mfma_f32_16x16x32_bf16 v[80:83], v[112:115], v[20:23], v[80:83]
    ds_read_b128 v[60:63], v13 offset:2432
    buffer_load_dwordx4 a[56:59], v206, s[56:59], s15 offen offset:2048 sc1
    v_mfma_f32_16x16x32_bf16 v[84:87], v[104:107], v[32:35], v[84:87]
    ds_read_b128 v[148:151], v12 offset:1408
    v_mfma_f32_16x16x32_bf16 v[84:87], v[112:115], v[24:27], v[84:87]
    ds_read_b128 v[64:67], v13 offset:2944
    s_waitcnt lgkmcnt(14)
    v_mfma_f32_16x16x32_bf16 v[80:83], v[96:99], v[36:39], v[80:83]
    ds_read_b128 v[152:155], v12 offset:896
    buffer_load_dwordx4 a[60:63], v206, s[56:59], s15 offen offset:3072 sc1
    v_mfma_f32_16x16x32_bf16 v[80:83], v[116:119], v[16:19], v[80:83]
    ds_read_b128 v[68:71], v13 offset:3456
    v_mfma_f32_16x16x32_bf16 v[84:87], v[100:103], v[36:39], v[84:87]
    v_mfma_f32_16x16x32_bf16 v[84:87], v[116:119], v[20:23], v[84:87]
    s_mov_b32 s15, 16384
    buffer_load_dwordx4 a[64:67], v206, s[56:59], s15 offen offset:0 sc1
    s_waitcnt lgkmcnt(14)
    v_mfma_f32_16x16x32_bf16 v[84:87], v[96:99], v[40:43], v[84:87]
    v_mfma_f32_16x16x32_bf16 v[84:87], v[120:123], v[16:19], v[84:87]
    buffer_load_dwordx4 a[68:71], v206, s[56:59], s15 offen offset:1024 sc1
    s_waitcnt lgkmcnt(10)
    v_mfma_f32_16x16x32_bf16 v[72:75], v[128:131], v[48:51], v[72:75]
    ds_read_b128 v[96:99], v12 offset:3904
    v_mfma_f32_16x16x32_bf16 v[72:75], v[132:135], v[44:47], v[72:75]
    ds_read_b128 v[16:19], v13 offset:320
    v_mfma_f32_16x16x32_bf16 v[76:79], v[132:135], v[48:51], v[76:79]
    ds_read_b128 v[100:103], v12 offset:3392
    s_waitcnt lgkmcnt(11)
    v_mfma_f32_16x16x32_bf16 v[76:79], v[128:131], v[52:55], v[76:79]
    ds_read_b128 v[20:23], v13 offset:832
    buffer_load_dwordx4 a[72:75], v206, s[56:59], s15 offen offset:2048 sc1
    v_mfma_f32_16x16x32_bf16 v[76:79], v[136:139], v[44:47], v[76:79]
    ds_read_b128 v[104:107], v12 offset:2880
    s_waitcnt lgkmcnt(11)
    v_mfma_f32_16x16x32_bf16 v[80:83], v[136:139], v[56:59], v[80:83]
    ds_read_b128 v[24:27], v13 offset:1344
    v_mfma_f32_16x16x32_bf16 v[80:83], v[140:143], v[52:55], v[80:83]
    ds_read_b128 v[108:111], v12 offset:2368
    buffer_load_dwordx4 a[76:79], v206, s[56:59], s15 offen offset:3072 sc1
    v_mfma_f32_16x16x32_bf16 v[84:87], v[140:143], v[56:59], v[84:87]
    ds_read_b128 v[28:31], v13 offset:1856
    s_waitcnt lgkmcnt(12)
    v_mfma_f32_16x16x32_bf16 v[80:83], v[132:135], v[60:63], v[80:83]
    ds_read_b128 v[112:115], v12 offset:1856
    v_mfma_f32_16x16x32_bf16 v[80:83], v[144:147], v[48:51], v[80:83]
    ds_read_b128 v[32:35], v13 offset:2368
    s_mov_b32 s15, 20480
    buffer_load_dwordx4 a[80:83], v206, s[56:59], s15 offen offset:0 sc1
    v_mfma_f32_16x16x32_bf16 v[84:87], v[136:139], v[60:63], v[84:87]
    ds_read_b128 v[116:119], v12 offset:1344
    v_mfma_f32_16x16x32_bf16 v[84:87], v[144:147], v[52:55], v[84:87]
    ds_read_b128 v[36:39], v13 offset:2880
    s_waitcnt lgkmcnt(14)
    v_mfma_f32_16x16x32_bf16 v[80:83], v[128:131], v[64:67], v[80:83]
    ds_read_b128 v[120:123], v12 offset:832
    buffer_load_dwordx4 a[84:87], v206, s[56:59], s15 offen offset:1024 sc1
    v_mfma_f32_16x16x32_bf16 v[80:83], v[148:151], v[44:47], v[80:83]
    ds_read_b128 v[40:43], v13 offset:3392
    v_mfma_f32_16x16x32_bf16 v[84:87], v[132:135], v[64:67], v[84:87]
    v_mfma_f32_16x16x32_bf16 v[84:87], v[148:151], v[48:51], v[84:87]
    buffer_load_dwordx4 a[88:91], v206, s[56:59], s15 offen offset:2048 sc1
    s_waitcnt lgkmcnt(14)
    v_mfma_f32_16x16x32_bf16 v[84:87], v[128:131], v[68:71], v[84:87]
    v_mfma_f32_16x16x32_bf16 v[84:87], v[152:155], v[44:47], v[84:87]
    buffer_load_dwordx4 a[92:95], v206, s[56:59], s15 offen offset:3072 sc1
    s_waitcnt lgkmcnt(10)
    v_mfma_f32_16x16x32_bf16 v[72:75], v[96:99], v[20:23], v[72:75]
    ds_read_b128 v[128:131], v12 offset:3840
    v_mfma_f32_16x16x32_bf16 v[72:75], v[100:103], v[16:19], v[72:75]
    ds_read_b128 v[44:47], v13 offset:256
    v_mfma_f32_16x16x32_bf16 v[76:79], v[100:103], v[20:23], v[76:79]
    ds_read_b128 v[132:135], v12 offset:3328
    s_waitcnt lgkmcnt(11)
    v_mfma_f32_16x16x32_bf16 v[76:79], v[96:99], v[24:27], v[76:79]
    ds_read_b128 v[48:51], v13 offset:768
    s_mov_b32 s15, 24576
    buffer_load_dwordx4 a[96:99], v206, s[56:59], s15 offen offset:0 sc1
    v_mfma_f32_16x16x32_bf16 v[76:79], v[104:107], v[16:19], v[76:79]
    ds_read_b128 v[136:139], v12 offset:2816
    s_waitcnt lgkmcnt(11)
    v_mfma_f32_16x16x32_bf16 v[80:83], v[104:107], v[28:31], v[80:83]
    ds_read_b128 v[52:55], v13 offset:1280
    v_mfma_f32_16x16x32_bf16 v[80:83], v[108:111], v[24:27], v[80:83]
    ds_read_b128 v[140:143], v12 offset:2304
    buffer_load_dwordx4 a[100:103], v206, s[56:59], s15 offen offset:1024 sc1
    v_mfma_f32_16x16x32_bf16 v[84:87], v[108:111], v[28:31], v[84:87]
    ds_read_b128 v[56:59], v13 offset:1792
    s_waitcnt lgkmcnt(12)
    v_mfma_f32_16x16x32_bf16 v[80:83], v[100:103], v[32:35], v[80:83]
    ds_read_b128 v[144:147], v12 offset:1792
    v_mfma_f32_16x16x32_bf16 v[80:83], v[112:115], v[20:23], v[80:83]
    ds_read_b128 v[60:63], v13 offset:2304
    buffer_load_dwordx4 a[104:107], v206, s[56:59], s15 offen offset:2048 sc1
    v_mfma_f32_16x16x32_bf16 v[84:87], v[104:107], v[32:35], v[84:87]
    ds_read_b128 v[148:151], v12 offset:1280
    v_mfma_f32_16x16x32_bf16 v[84:87], v[112:115], v[24:27], v[84:87]
    ds_read_b128 v[64:67], v13 offset:2816
    s_waitcnt lgkmcnt(14)
    v_mfma_f32_16x16x32_bf16 v[80:83], v[96:99], v[36:39], v[80:83]
    ds_read_b128 v[152:155], v12 offset:768
    buffer_load_dwordx4 a[108:111], v206, s[56:59], s15 offen offset:3072 sc1
    v_mfma_f32_16x16x32_bf16 v[80:83], v[116:119], v[16:19], v[80:83]
    ds_read_b128 v[68:71], v13 offset:3328
    v_mfma_f32_16x16x32_bf16 v[84:87], v[100:103], v[36:39], v[84:87]
    v_mfma_f32_16x16x32_bf16 v[84:87], v[116:119], v[20:23], v[84:87]
    s_mov_b32 s15, 28672
    buffer_load_dwordx4 a[112:115], v206, s[56:59], s15 offen offset:0 sc1
    s_waitcnt lgkmcnt(14)
    v_mfma_f32_16x16x32_bf16 v[84:87], v[96:99], v[40:43], v[84:87]
    v_mfma_f32_16x16x32_bf16 v[84:87], v[120:123], v[16:19], v[84:87]
    buffer_load_dwordx4 a[116:119], v206, s[56:59], s15 offen offset:1024 sc1
    s_waitcnt lgkmcnt(10)
    v_mfma_f32_16x16x32_bf16 v[72:75], v[128:131], v[48:51], v[72:75]
    ds_read_b128 v[96:99], v12 offset:3776
    v_mfma_f32_16x16x32_bf16 v[72:75], v[132:135], v[44:47], v[72:75]
    ds_read_b128 v[16:19], v13 offset:192
    v_mfma_f32_16x16x32_bf16 v[76:79], v[132:135], v[48:51], v[76:79]
    ds_read_b128 v[100:103], v12 offset:3264
    s_waitcnt lgkmcnt(11)
    v_mfma_f32_16x16x32_bf16 v[76:79], v[128:131], v[52:55], v[76:79]
    ds_read_b128 v[20:23], v13 offset:704
    buffer_load_dwordx4 a[120:123], v206, s[56:59], s15 offen offset:2048 sc1
    v_mfma_f32_16x16x32_bf16 v[76:79], v[136:139], v[44:47], v[76:79]
    ds_read_b128 v[104:107], v12 offset:2752
    s_waitcnt lgkmcnt(11)
    v_mfma_f32_16x16x32_bf16 v[80:83], v[136:139], v[56:59], v[80:83]
    ds_read_b128 v[24:27], v13 offset:1216
    v_mfma_f32_16x16x32_bf16 v[80:83], v[140:143], v[52:55], v[80:83]
    ds_read_b128 v[108:111], v12 offset:2240
    buffer_load_dwordx4 a[124:127], v206, s[56:59], s15 offen offset:3072 sc1
    v_mfma_f32_16x16x32_bf16 v[84:87], v[140:143], v[56:59], v[84:87]
    ds_read_b128 v[28:31], v13 offset:1728
    s_waitcnt lgkmcnt(12)
    v_mfma_f32_16x16x32_bf16 v[80:83], v[132:135], v[60:63], v[80:83]
    ds_read_b128 v[112:115], v12 offset:1728
    v_mfma_f32_16x16x32_bf16 v[80:83], v[144:147], v[48:51], v[80:83]
    ds_read_b128 v[32:35], v13 offset:2240
    s_mov_b32 s15, 32768
    buffer_load_dwordx4 a[128:131], v206, s[56:59], s15 offen offset:0 sc1
    v_mfma_f32_16x16x32_bf16 v[84:87], v[136:139], v[60:63], v[84:87]
    ds_read_b128 v[116:119], v12 offset:1216
    v_mfma_f32_16x16x32_bf16 v[84:87], v[144:147], v[52:55], v[84:87]
    ds_read_b128 v[36:39], v13 offset:2752
    s_waitcnt lgkmcnt(14)
    v_mfma_f32_16x16x32_bf16 v[80:83], v[128:131], v[64:67], v[80:83]
    ds_read_b128 v[120:123], v12 offset:704
    buffer_load_dwordx4 a[132:135], v206, s[56:59], s15 offen offset:1024 sc1
    v_mfma_f32_16x16x32_bf16 v[80:83], v[148:151], v[44:47], v[80:83]
    ds_read_b128 v[40:43], v13 offset:3264
    v_mfma_f32_16x16x32_bf16 v[84:87], v[132:135], v[64:67], v[84:87]
    v_mfma_f32_16x16x32_bf16 v[84:87], v[148:151], v[48:51], v[84:87]
    buffer_load_dwordx4 a[136:139], v206, s[56:59], s15 offen offset:2048 sc1
    s_waitcnt lgkmcnt(14)
    v_mfma_f32_16x16x32_bf16 v[84:87], v[128:131], v[68:71], v[84:87]
    v_mfma_f32_16x16x32_bf16 v[84:87], v[152:155], v[44:47], v[84:87]
    buffer_load_dwordx4 a[140:143], v206, s[56:59], s15 offen offset:3072 sc1
    s_waitcnt lgkmcnt(10)
    v_mfma_f32_16x16x32_bf16 v[72:75], v[96:99], v[20:23], v[72:75]
    ds_read_b128 v[128:131], v12 offset:3712
    v_mfma_f32_16x16x32_bf16 v[72:75], v[100:103], v[16:19], v[72:75]
    ds_read_b128 v[44:47], v13 offset:128
    v_mfma_f32_16x16x32_bf16 v[76:79], v[100:103], v[20:23], v[76:79]
    ds_read_b128 v[132:135], v12 offset:3200
    s_waitcnt lgkmcnt(11)
    v_mfma_f32_16x16x32_bf16 v[76:79], v[96:99], v[24:27], v[76:79]
    ds_read_b128 v[48:51], v13 offset:640
    s_mov_b32 s15, 36864
    buffer_load_dwordx4 a[144:147], v206, s[56:59], s15 offen offset:0 sc1
    v_mfma_f32_16x16x32_bf16 v[76:79], v[104:107], v[16:19], v[76:79]
    ds_read_b128 v[136:139], v12 offset:2688
    s_waitcnt lgkmcnt(11)
    v_mfma_f32_16x16x32_bf16 v[80:83], v[104:107], v[28:31], v[80:83]
    ds_read_b128 v[52:55], v13 offset:1152
    v_mfma_f32_16x16x32_bf16 v[80:83], v[108:111], v[24:27], v[80:83]
    ds_read_b128 v[140:143], v12 offset:2176
    buffer_load_dwordx4 a[148:151], v206, s[56:59], s15 offen offset:1024 sc1
    v_mfma_f32_16x16x32_bf16 v[84:87], v[108:111], v[28:31], v[84:87]
    ds_read_b128 v[56:59], v13 offset:1664
    s_waitcnt lgkmcnt(12)
    v_mfma_f32_16x16x32_bf16 v[80:83], v[100:103], v[32:35], v[80:83]
    ds_read_b128 v[144:147], v12 offset:1664
    v_mfma_f32_16x16x32_bf16 v[80:83], v[112:115], v[20:23], v[80:83]
    ds_read_b128 v[60:63], v13 offset:2176
    buffer_load_dwordx4 a[152:155], v206, s[56:59], s15 offen offset:2048 sc1
    v_mfma_f32_16x16x32_bf16 v[84:87], v[104:107], v[32:35], v[84:87]
    ds_read_b128 v[148:151], v12 offset:1152
    v_mfma_f32_16x16x32_bf16 v[84:87], v[112:115], v[24:27], v[84:87]
    ds_read_b128 v[64:67], v13 offset:2688
    s_waitcnt lgkmcnt(14)
    v_mfma_f32_16x16x32_bf16 v[80:83], v[96:99], v[36:39], v[80:83]
    ds_read_b128 v[152:155], v12 offset:640
    buffer_load_dwordx4 a[156:159], v206, s[56:59], s15 offen offset:3072 sc1
    v_mfma_f32_16x16x32_bf16 v[80:83], v[116:119], v[16:19], v[80:83]
    ds_read_b128 v[68:71], v13 offset:3200
    v_mfma_f32_16x16x32_bf16 v[84:87], v[100:103], v[36:39], v[84:87]
    v_mfma_f32_16x16x32_bf16 v[84:87], v[116:119], v[20:23], v[84:87]
    s_mov_b32 s15, 40960
    buffer_load_dwordx4 a[160:163], v206, s[56:59], s15 offen offset:0 sc1
    s_waitcnt lgkmcnt(14)
    v_mfma_f32_16x16x32_bf16 v[84:87], v[96:99], v[40:43], v[84:87]
    v_mfma_f32_16x16x32_bf16 v[84:87], v[120:123], v[16:19], v[84:87]
    buffer_load_dwordx4 a[164:167], v206, s[56:59], s15 offen offset:1024 sc1
    s_waitcnt lgkmcnt(10)
    v_mfma_f32_16x16x32_bf16 v[72:75], v[128:131], v[48:51], v[72:75]
    ds_read_b128 v[96:99], v12 offset:3648
    v_mfma_f32_16x16x32_bf16 v[72:75], v[132:135], v[44:47], v[72:75]
    ds_read_b128 v[16:19], v13 offset:64
    v_mfma_f32_16x16x32_bf16 v[76:79], v[132:135], v[48:51], v[76:79]
    ds_read_b128 v[100:103], v12 offset:3136
    s_waitcnt lgkmcnt(11)
    v_mfma_f32_16x16x32_bf16 v[76:79], v[128:131], v[52:55], v[76:79]
    ds_read_b128 v[20:23], v13 offset:576
    buffer_load_dwordx4 a[168:171], v206, s[56:59], s15 offen offset:2048 sc1
    v_mfma_f32_16x16x32_bf16 v[76:79], v[136:139], v[44:47], v[76:79]
    ds_read_b128 v[104:107], v12 offset:2624
    s_waitcnt lgkmcnt(11)
    v_mfma_f32_16x16x32_bf16 v[80:83], v[136:139], v[56:59], v[80:83]
    ds_read_b128 v[24:27], v13 offset:1088
    v_mfma_f32_16x16x32_bf16 v[80:83], v[140:143], v[52:55], v[80:83]
    ds_read_b128 v[108:111], v12 offset:2112
    buffer_load_dwordx4 a[172:175], v206, s[56:59], s15 offen offset:3072 sc1
    v_mfma_f32_16x16x32_bf16 v[84:87], v[140:143], v[56:59], v[84:87]
    ds_read_b128 v[28:31], v13 offset:1600
    s_waitcnt lgkmcnt(12)
    v_mfma_f32_16x16x32_bf16 v[80:83], v[132:135], v[60:63], v[80:83]
    ds_read_b128 v[112:115], v12 offset:1600
    v_mfma_f32_16x16x32_bf16 v[80:83], v[144:147], v[48:51], v[80:83]
    ds_read_b128 v[32:35], v13 offset:2112
    s_mov_b32 s15, 45056
    buffer_load_dwordx4 a[176:179], v206, s[56:59], s15 offen offset:0 sc1
    v_mfma_f32_16x16x32_bf16 v[84:87], v[136:139], v[60:63], v[84:87]
    ds_read_b128 v[116:119], v12 offset:1088
    v_mfma_f32_16x16x32_bf16 v[84:87], v[144:147], v[52:55], v[84:87]
    ds_read_b128 v[36:39], v13 offset:2624
    s_waitcnt lgkmcnt(14)
    v_mfma_f32_16x16x32_bf16 v[80:83], v[128:131], v[64:67], v[80:83]
    ds_read_b128 v[120:123], v12 offset:576
    buffer_load_dwordx4 a[180:183], v206, s[56:59], s15 offen offset:1024 sc1
    v_mfma_f32_16x16x32_bf16 v[80:83], v[148:151], v[44:47], v[80:83]
    ds_read_b128 v[40:43], v13 offset:3136
    v_mfma_f32_16x16x32_bf16 v[84:87], v[132:135], v[64:67], v[84:87]
    v_mfma_f32_16x16x32_bf16 v[84:87], v[148:151], v[48:51], v[84:87]
    buffer_load_dwordx4 a[184:187], v206, s[56:59], s15 offen offset:2048 sc1
    s_waitcnt lgkmcnt(14)
    v_mfma_f32_16x16x32_bf16 v[84:87], v[128:131], v[68:71], v[84:87]
    v_mfma_f32_16x16x32_bf16 v[84:87], v[152:155], v[44:47], v[84:87]
    buffer_load_dwordx4 a[188:191], v206, s[56:59], s15 offen offset:3072 sc1
    s_waitcnt lgkmcnt(10)
    v_mfma_f32_16x16x32_bf16 v[72:75], v[96:99], v[20:23], v[72:75]
    ds_read_b128 v[128:131], v12 offset:3584
    v_mfma_f32_16x16x32_bf16 v[72:75], v[100:103], v[16:19], v[72:75]
    ds_read_b128 v[44:47], v13 offset:0
    v_mfma_f32_16x16x32_bf16 v[76:79], v[100:103], v[20:23], v[76:79]
    ds_read_b128 v[132:135], v12 offset:3072
    s_waitcnt lgkmcnt(11)
    v_mfma_f32_16x16x32_bf16 v[76:79], v[96:99], v[24:27], v[76:79]
    ds_read_b128 v[48:51], v13 offset:512
    s_mov_b32 s15, 49152
    buffer_load_dwordx4 a[192:195], v206, s[56:59], s15 offen offset:0 sc1
    v_mfma_f32_16x16x32_bf16 v[76:79], v[104:107], v[16:19], v[76:79]
    ds_read_b128 v[136:139], v12 offset:2560
    s_waitcnt lgkmcnt(11)
    v_mfma_f32_16x16x32_bf16 v[80:83], v[104:107], v[28:31], v[80:83]
    ds_read_b128 v[52:55], v13 offset:1024
    v_mfma_f32_16x16x32_bf16 v[80:83], v[108:111], v[24:27], v[80:83]
    ds_read_b128 v[140:143], v12 offset:2048
    v_mfma_f32_16x16x32_bf16 v[84:87], v[108:111], v[28:31], v[84:87]
    ds_read_b128 v[56:59], v13 offset:1536
    s_waitcnt lgkmcnt(12)
    v_mfma_f32_16x16x32_bf16 v[80:83], v[100:103], v[32:35], v[80:83]
    ds_read_b128 v[144:147], v12 offset:1536
    v_mfma_f32_16x16x32_bf16 v[80:83], v[112:115], v[20:23], v[80:83]
    ds_read_b128 v[60:63], v13 offset:2048
    v_mfma_f32_16x16x32_bf16 v[84:87], v[104:107], v[32:35], v[84:87]
    ds_read_b128 v[148:151], v12 offset:1024
    v_mfma_f32_16x16x32_bf16 v[84:87], v[112:115], v[24:27], v[84:87]
    ds_read_b128 v[64:67], v13 offset:2560
    s_waitcnt lgkmcnt(14)
    v_mfma_f32_16x16x32_bf16 v[80:83], v[96:99], v[36:39], v[80:83]
    ds_read_b128 v[152:155], v12 offset:512
    v_mfma_f32_16x16x32_bf16 v[80:83], v[116:119], v[16:19], v[80:83]
    ds_read_b128 v[68:71], v13 offset:3072
    v_mfma_f32_16x16x32_bf16 v[84:87], v[100:103], v[36:39], v[84:87]
    v_mfma_f32_16x16x32_bf16 v[84:87], v[116:119], v[20:23], v[84:87]
    s_waitcnt lgkmcnt(14)
    v_mfma_f32_16x16x32_bf16 v[84:87], v[96:99], v[40:43], v[84:87]
    v_mfma_f32_16x16x32_bf16 v[84:87], v[120:123], v[16:19], v[84:87]
    s_waitcnt lgkmcnt(10)
    v_mfma_f32_16x16x32_bf16 v[72:75], v[128:131], v[48:51], v[72:75]
    v_mfma_f32_16x16x32_bf16 v[72:75], v[132:135], v[44:47], v[72:75]
    v_mfma_f32_16x16x32_bf16 v[76:79], v[132:135], v[48:51], v[76:79]
    s_waitcnt lgkmcnt(8)
    v_mfma_f32_16x16x32_bf16 v[76:79], v[128:131], v[52:55], v[76:79]
    v_mfma_f32_16x16x32_bf16 v[76:79], v[136:139], v[44:47], v[76:79]
    s_waitcnt lgkmcnt(6)
    v_mfma_f32_16x16x32_bf16 v[80:83], v[136:139], v[56:59], v[80:83]
    v_mfma_f32_16x16x32_bf16 v[80:83], v[140:143], v[52:55], v[80:83]
    v_mfma_f32_16x16x32_bf16 v[84:87], v[140:143], v[56:59], v[84:87]
    s_waitcnt lgkmcnt(4)
    v_mfma_f32_16x16x32_bf16 v[80:83], v[132:135], v[60:63], v[80:83]
    v_mfma_f32_16x16x32_bf16 v[80:83], v[144:147], v[48:51], v[80:83]
    v_mfma_f32_16x16x32_bf16 v[84:87], v[136:139], v[60:63], v[84:87]
    v_mfma_f32_16x16x32_bf16 v[84:87], v[144:147], v[52:55], v[84:87]
    s_waitcnt lgkmcnt(2)
    v_mfma_f32_16x16x32_bf16 v[80:83], v[128:131], v[64:67], v[80:83]
    v_mfma_f32_16x16x32_bf16 v[80:83], v[148:151], v[44:47], v[80:83]
    v_mfma_f32_16x16x32_bf16 v[84:87], v[132:135], v[64:67], v[84:87]
    v_mfma_f32_16x16x32_bf16 v[84:87], v[148:151], v[48:51], v[84:87]
    s_waitcnt lgkmcnt(0)
    v_mfma_f32_16x16x32_bf16 v[84:87], v[128:131], v[68:71], v[84:87]
    v_mfma_f32_16x16x32_bf16 v[84:87], v[152:155], v[44:47], v[84:87]
    s_barrier
    s_mul_i32 s9, s8, 4608
    s_add_u32 s9, s9, 67072
    v_lshlrev_b32 v5, 5, v2
    v_lshl_add_u32 v5, v3, 3, v5
    v_add_u32 v6, s9, v5
    s_mul_i32 s9, s8, 4224
    v_add_u32 v7, s9, v5
    ds_read_b64 v[96:97], v6 offset:512
    ds_read_b64 v[98:99], v6 offset:1024
    ds_read_b64 v[100:101], v6 offset:2560
    ds_read_b64 v[102:103], v6 offset:3072
    v_mov_b32 v8, 0xffff0000
    s_waitcnt lgkmcnt(3)
    v_lshlrev_b32 v16, 16, v96
    v_and_b32 v17, v8, v96
    v_lshlrev_b32 v18, 16, v97
    v_and_b32 v19, v8, v97
    v_fma_f32 v16, v16, s14, v72
    v_fma_f32 v17, v17, s14, v73
    v_fma_f32 v18, v18, s14, v74
    v_fma_f32 v19, v19, s14, v75
    v_cvt_pk_bf16_f32 v16, v16, v17
    v_cvt_pk_bf16_f32 v17, v18, v19
    ds_write_b64 v7, v[16:17] offset:512
    s_waitcnt lgkmcnt(3)
    v_lshlrev_b32 v20, 16, v98
    v_and_b32 v21, v8, v98
    v_lshlrev_b32 v22, 16, v99
    v_and_b32 v23, v8, v99
    v_fma_f32 v20, v20, s14, v76
    v_fma_f32 v21, v21, s14, v77
    v_fma_f32 v22, v22, s14, v78
    v_fma_f32 v23, v23, s14, v79
    v_cvt_pk_bf16_f32 v20, v20, v21
    v_cvt_pk_bf16_f32 v21, v22, v23
    ds_write_b64 v7, v[20:21] offset:1024
    s_waitcnt lgkmcnt(3)
    v_lshlrev_b32 v24, 16, v100
    v_and_b32 v25, v8, v100
    v_lshlrev_b32 v26, 16, v101
    v_and_b32 v27, v8, v101
    v_fma_f32 v24, v24, s14, v80
    v_fma_f32 v25, v25, s14, v81
    v_fma_f32 v26, v26, s14, v82
    v_fma_f32 v27, v27, s14, v83
    v_cvt_pk_bf16_f32 v24, v24, v25
    v_cvt_pk_bf16_f32 v25, v26, v27
    ds_write_b64 v7, v[24:25] offset:2560
    s_waitcnt lgkmcnt(3)
    v_lshlrev_b32 v28, 16, v102
    v_and_b32 v29, v8, v102
    v_lshlrev_b32 v30, 16, v103
    v_and_b32 v31, v8, v103
    v_fma_f32 v28, v28, s14, v84
    v_fma_f32 v29, v29, s14, v85
    v_fma_f32 v30, v30, s14, v86
    v_fma_f32 v31, v31, s14, v87
    v_cvt_pk_bf16_f32 v28, v28, v29
    v_cvt_pk_bf16_f32 v29, v30, v31
    ds_write_b64 v7, v[28:29] offset:3072
    s_waitcnt lgkmcnt(0)
cjoin_18:
    s_barrier
    v_and_b32 v1, 3, v0
    v_lshrrev_b32 v2, 2, v0
    v_lshrrev_b32 v3, 1, v1
    v_and_b32 v4, 1, v1
    v_mul_u32_u24 v3, 4224, v3
    v_lshl_add_u32 v3, v4, 4, v3
    v_lshl_add_u32 v3, v2, 5, v3
    ds_read_b128 v[16:19], v3
    ds_read_b128 v[20:23], v3 offset:2048
    v_mul_u32_u24 v5, 14336, v2
    v_lshl_add_u32 v5, v1, 4, v5
    s_lshl_b32 s9, s2, 6
    v_add_u32 v5, s9, v5
    v_add_u32 v6, 917504, v5
    s_waitcnt lgkmcnt(1)
    buffer_store_dwordx4 v[16:19], v5, s[52:55], 0 offen sc1
    s_waitcnt lgkmcnt(0)
    buffer_store_dwordx4 v[20:23], v6, s[52:55], 0 offen sc1
    s_waitcnt vmcnt(0)
    s_barrier
    s_cmp_eq_u32 s3, 0
    s_cbranch_scc0 sigr_19
    s_lshl_b32 s90, s2, 3
    s_add_u32 s90, s90, 32768
    v_mov_b32 v250, s84
    v_mov_b32 v251, s85
    v_lshlrev_b32 v1, 11, v0
    v_add_u32 v1, s90, v1
    s_mov_b64 exec, 0xff
    buffer_store_dwordx2 v[250:251], v1, s[64:67], 0 offen sc1
    s_mov_b64 exec, -1
sigr_19:
    s_branch K_convdone
K_noconv:
    s_mov_b32 s15, 0
    buffer_load_dwordx4 a[0:3], v206, s[56:59], s15 offen offset:0 sc1
    buffer_load_dwordx4 a[4:7], v206, s[56:59], s15 offen offset:1024 sc1
    buffer_load_dwordx4 a[8:11], v206, s[56:59], s15 offen offset:2048 sc1
    buffer_load_dwordx4 a[12:15], v206, s[56:59], s15 offen offset:3072 sc1
    s_mov_b32 s15, 4096
    buffer_load_dwordx4 a[16:19], v206, s[56:59], s15 offen offset:0 sc1
    buffer_load_dwordx4 a[20:23], v206, s[56:59], s15 offen offset:1024 sc1
    buffer_load_dwordx4 a[24:27], v206, s[56:59], s15 offen offset:2048 sc1
    buffer_load_dwordx4 a[28:31], v206, s[56:59], s15 offen offset:3072 sc1
    s_mov_b32 s15, 8192
    buffer_load_dwordx4 a[32:35], v206, s[56:59], s15 offen offset:0 sc1
    buffer_load_dwordx4 a[36:39], v206, s[56:59], s15 offen offset:1024 sc1
    buffer_load_dwordx4 a[40:43], v206, s[56:59], s15 offen offset:2048 sc1
    buffer_load_dwordx4 a[44:47], v206, s[56:59], s15 offen offset:3072 sc1
    s_mov_b32 s15, 12288
    buffer_load_dwordx4 a[48:51], v206, s[56:59], s15 offen offset:0 sc1
    buffer_load_dwordx4 a[52:55], v206, s[56:59], s15 offen offset:1024 sc1
    buffer_load_dwordx4 a[56:59], v206, s[56:59], s15 offen offset:2048 sc1
    buffer_load_dwordx4 a[60:63], v206, s[56:59], s15 offen offset:3072 sc1
    s_mov_b32 s15, 16384
    buffer_load_dwordx4 a[64:67], v206, s[56:59], s15 offen offset:0 sc1
    buffer_load_dwordx4 a[68:71], v206, s[56:59], s15 offen offset:1024 sc1
    buffer_load_dwordx4 a[72:75], v206, s[56:59], s15 offen offset:2048 sc1
    buffer_load_dwordx4 a[76:79], v206, s[56:59], s15 offen offset:3072 sc1
    s_mov_b32 s15, 20480
    buffer_load_dwordx4 a[80:83], v206, s[56:59], s15 offen offset:0 sc1
    buffer_load_dwordx4 a[84:87], v206, s[56:59], s15 offen offset:1024 sc1
    buffer_load_dwordx4 a[88:91], v206, s[56:59], s15 offen offset:2048 sc1
    buffer_load_dwordx4 a[92:95], v206, s[56:59], s15 offen offset:3072 sc1
    s_mov_b32 s15, 24576
    buffer_load_dwordx4 a[96:99], v206, s[56:59], s15 offen offset:0 sc1
    buffer_load_dwordx4 a[100:103], v206, s[56:59], s15 offen offset:1024 sc1
    buffer_load_dwordx4 a[104:107], v206, s[56:59], s15 offen offset:2048 sc1
    buffer_load_dwordx4 a[108:111], v206, s[56:59], s15 offen offset:3072 sc1
    s_mov_b32 s15, 28672
    buffer_load_dwordx4 a[112:115], v206, s[56:59], s15 offen offset:0 sc1
    buffer_load_dwordx4 a[116:119], v206, s[56:59], s15 offen offset:1024 sc1
    buffer_load_dwordx4 a[120:123], v206, s[56:59], s15 offen offset:2048 sc1
    buffer_load_dwordx4 a[124:127], v206, s[56:59], s15 offen offset:3072 sc1
    s_mov_b32 s15, 32768
    buffer_load_dwordx4 a[128:131], v206, s[56:59], s15 offen offset:0 sc1
    buffer_load_dwordx4 a[132:135], v206, s[56:59], s15 offen offset:1024 sc1
    buffer_load_dwordx4 a[136:139], v206, s[56:59], s15 offen offset:2048 sc1
    buffer_load_dwordx4 a[140:143], v206, s[56:59], s15 offen offset:3072 sc1
    s_mov_b32 s15, 36864
    buffer_load_dwordx4 a[144:147], v206, s[56:59], s15 offen offset:0 sc1
    buffer_load_dwordx4 a[148:151], v206, s[56:59], s15 offen offset:1024 sc1
    buffer_load_dwordx4 a[152:155], v206, s[56:59], s15 offen offset:2048 sc1
    buffer_load_dwordx4 a[156:159], v206, s[56:59], s15 offen offset:3072 sc1
    s_mov_b32 s15, 40960
    buffer_load_dwordx4 a[160:163], v206, s[56:59], s15 offen offset:0 sc1
    buffer_load_dwordx4 a[164:167], v206, s[56:59], s15 offen offset:1024 sc1
    buffer_load_dwordx4 a[168:171], v206, s[56:59], s15 offen offset:2048 sc1
    buffer_load_dwordx4 a[172:175], v206, s[56:59], s15 offen offset:3072 sc1
    s_mov_b32 s15, 45056
    buffer_load_dwordx4 a[176:179], v206, s[56:59], s15 offen offset:0 sc1
    buffer_load_dwordx4 a[180:183], v206, s[56:59], s15 offen offset:1024 sc1
    buffer_load_dwordx4 a[184:187], v206, s[56:59], s15 offen offset:2048 sc1
    buffer_load_dwordx4 a[188:191], v206, s[56:59], s15 offen offset:3072 sc1
    s_mov_b32 s15, 49152
    buffer_load_dwordx4 a[192:195], v206, s[56:59], s15 offen offset:0 sc1
    s_waitcnt vmcnt(0)
K_convdone:
    s_waitcnt vmcnt(0)
    v_mov_b32 v7, 0xffff0000
    v_lshlrev_b32 v16, 16, v224
    v_and_b32 v17, v7, v224
    v_lshlrev_b32 v18, 16, v225
    v_and_b32 v19, v7, v225
    v_lshlrev_b32 v20, 16, v226
    v_and_b32 v21, v7, v226
    v_lshlrev_b32 v22, 16, v227
    v_and_b32 v23, v7, v227
    v_lshlrev_b32 v24, 16, v228
    v_and_b32 v25, v7, v228
    v_lshlrev_b32 v26, 16, v229
    v_and_b32 v27, v7, v229
    v_lshlrev_b32 v28, 16, v230
    v_and_b32 v29, v7, v230
    v_lshlrev_b32 v30, 16, v231
    v_and_b32 v31, v7, v231
    v_pk_add_f32 v[72:73], v[16:17], v[18:19]
    v_pk_add_f32 v[74:75], v[20:21], v[22:23]
    v_pk_add_f32 v[76:77], v[24:25], v[26:27]
    v_pk_add_f32 v[78:79], v[28:29], v[30:31]
    v_pk_add_f32 v[72:73], v[72:73], v[74:75]
    v_pk_add_f32 v[76:77], v[76:77], v[78:79]
    v_pk_add_f32 v[72:73], v[72:73], v[76:77]
    v_add_f32 v80, v72, v73
    v_cndmask_b32 v80, 0, v80, s[88:89]
    s_nop 1
    v_add_f32_dpp v80, v80, v80 quad_perm:[1,0,3,2] row_mask:0xf bank_mask:0xf
    s_nop 1
    v_add_f32_dpp v80, v80, v80 quad_perm:[2,3,0,1] row_mask:0xf bank_mask:0xf
    s_nop 1
    v_add_f32_dpp v80, v80, v80 row_half_mirror row_mask:0xf bank_mask:0xf
    s_nop 1
    v_add_f32_dpp v80, v80, v80 row_mirror row_mask:0xf bank_mask:0xf
    v_mov_b32 v81, v80
    s_nop 1
    v_permlane16_swap_b32 v80, v81
    v_add_f32 v80, v80, v81
    v_mul_f32 v80, 0xbb124925, v80
    v_mov_b32 v81, v80
    v_pk_add_f32 v[32:33], v[16:17], v[80:81]
    v_pk_add_f32 v[34:35], v[18:19], v[80:81]
    v_pk_add_f32 v[36:37], v[20:21], v[80:81]
    v_pk_add_f32 v[38:39], v[22:23], v[80:81]
    v_pk_add_f32 v[40:41], v[24:25], v[80:81]
    v_pk_add_f32 v[42:43], v[26:27], v[80:81]
    v_pk_add_f32 v[44:45], v[28:29], v[80:81]
    v_pk_add_f32 v[46:47], v[30:31], v[80:81]
    v_pk_mul_f32 v[72:73], v[32:33], v[32:33]
    v_pk_mul_f32 v[74:75], v[34:35], v[34:35]
    v_pk_fma_f32 v[72:73], v[36:37], v[36:37], v[72:73]
    v_pk_fma_f32 v[74:75], v[38:39], v[38:39], v[74:75]
    v_pk_fma_f32 v[72:73], v[40:41], v[40:41], v[72:73]
    v_pk_fma_f32 v[74:75], v[42:43], v[42:43], v[74:75]
    v_pk_fma_f32 v[72:73], v[44:45], v[44:45], v[72:73]
    v_pk_fma_f32 v[74:75], v[46:47], v[46:47], v[74:75]
    v_pk_add_f32 v[72:73], v[72:73], v[74:75]
    v_add_f32 v82, v72, v73
    v_cndmask_b32 v82, 0, v82, s[88:89]
    s_nop 1
    v_add_f32_dpp v82, v82, v82 quad_perm:[1,0,3,2] row_mask:0xf bank_mask:0xf
    s_nop 1
    v_add_f32_dpp v82, v82, v82 quad_perm:[2,3,0,1] row_mask:0xf bank_mask:0xf
    s_nop 1
    v_add_f32_dpp v82, v82, v82 row_half_mirror row_mask:0xf bank_mask:0xf
    s_nop 1
    v_add_f32_dpp v82, v82, v82 row_mirror row_mask:0xf bank_mask:0xf
    v_mov_b32 v83, v82
    s_nop 1
    v_permlane16_swap_b32 v82, v83
    v_add_f32 v82, v82, v83
    v_mov_b32 v83, 0x3727c5ac
    v_fmac_f32 v83, 0x3b124925, v82
    v_rsq_f32 v82, v83
    s_nop 0
    v_mov_b32 v83, v82
    v_pk_mul_f32 v[32:33], v[32:33], v[82:83]
    v_pk_mul_f32 v[34:35], v[34:35], v[82:83]
    v_pk_mul_f32 v[36:37], v[36:37], v[82:83]
    v_pk_mul_f32 v[38:39], v[38:39], v[82:83]
    v_pk_mul_f32 v[40:41], v[40:41], v[82:83]
    v_pk_mul_f32 v[42:43], v[42:43], v[82:83]
    v_pk_mul_f32 v[44:45], v[44:45], v[82:83]
    v_pk_mul_f32 v[46:47], v[46:47], v[82:83]
    v_and_b32 v1, 63, v0
    s_and_b32 s9, s2, 7
    s_lshl_b32 s9, s9, 11
    s_add_u32 s9, s9, 32768
    v_lshl_add_u32 v12, v1, 3, s9
    v_lshl_add_u32 v13, v1, 3, s9
    v_add_u32 v13, 512, v13
    v_lshl_add_u32 v14, v1, 3, s9
    v_add_u32 v14, 1024, v14
    v_lshl_add_u32 v15, v1, 3, s9
    v_add_u32 v15, 1536, v15
    v_and_b32 v48, 7, v0
    s_lshl_b32 s9, s5, 6
    s_add_u32 s9, s9, 6144
    v_lshl_add_u32 v48, v48, 3, s9
    s_cmp_eq_u32 s3, 0
    s_cbranch_scc0 s2s_22
    s_mov_b32 s90, 0
s2_20:
    s_mov_b32 exec_lo, -1
    s_mov_b32 exec_hi, -1
    buffer_load_dwordx2 v[2:3], v12, s[64:67], 0 offen sc1
    s_mov_b32 exec_lo, -1
    s_mov_b32 exec_hi, -1
    buffer_load_dwordx2 v[4:5], v13, s[64:67], 0 offen sc1
    s_mov_b32 exec_lo, -1
    s_mov_b32 exec_hi, -1
    buffer_load_dwordx2 v[6:7], v14, s[64:67], 0 offen sc1
    s_mov_b32 exec_lo, -1
    s_mov_b32 exec_hi, 0x0
    buffer_load_dwordx2 v[8:9], v15, s[64:67], 0 offen sc1
    s_mov_b64 exec, -1
    buffer_load_dwordx2 v[10:11], v48, s[64:67], 0 offen sc1
    s_waitcnt vmcnt(0)
    v_subrev_u32 v10, s84, v10
    v_cmp_eq_u32 vcc, s85, v11
    v_cmp_gt_u32 s[10:11], 16, v10
    s_nop 4
    s_and_b64 vcc, vcc, s[10:11]
    s_cmp_eq_u64 vcc, exec
    s_cselect_b32 s9, 1, 0
    s_mov_b32 exec_lo, -1
    s_mov_b32 exec_hi, -1
    v_cmp_eq_u64 vcc, s[84:85], v[2:3]
    s_nop 4
    s_cmp_eq_u64 vcc, exec
    s_cselect_b32 s9, s9, 0
    s_mov_b32 exec_lo, -1
    s_mov_b32 exec_hi, -1
    v_cmp_eq_u64 vcc, s[84:85], v[4:5]
    s_nop 4
    s_cmp_eq_u64 vcc, exec
    s_cselect_b32 s9, s9, 0
    s_mov_b32 exec_lo, -1
    s_mov_b32 exec_hi, -1
    v_cmp_eq_u64 vcc, s[84:85], v[6:7]
    s_nop 4
    s_cmp_eq_u64 vcc, exec
    s_cselect_b32 s9, s9, 0
    s_mov_b32 exec_lo, -1
    s_mov_b32 exec_hi, 0x0
    v_cmp_eq_u64 vcc, s[84:85], v[8:9]
    s_nop 4
    s_cmp_eq_u64 vcc, exec
    s_cselect_b32 s9, s9, 0
    s_mov_b64 exec, -1
    s_cmp_eq_u32 s9, 1
    s_cbranch_scc1 s2d_21
    s_add_u32 s90, s90, 1
    s_cmp_lt_u32 s90, 0x100000
    s_cbranch_scc0 s2d_21
    s_sleep 1
    s_branch s2_20
s2d_21:
    s_getreg_b32 s9, hwreg(HW_REG_XCC_ID, 0, 4)
    v_cmp_eq_u32 vcc, s9, v10
    s_nop 4
    s_cmp_eq_u64 vcc, exec
    s_cselect_b32 s9, 1, 0
    v_mov_b32 v2, s9
    v_mov_b32 v3, 163776
    ds_write_b32 v3, v2
    s_waitcnt lgkmcnt(0)
s2s_22:
    s_barrier
    v_mov_b32 v3, 163776
    ds_read_b32 v49, v3
    s_lshr_b32 s9, s4, 1
    s_mul_i32 s9, s9, 14336
    s_and_b32 s10, s4, 1
    s_lshl_b32 s10, s10, 4
    s_add_u32 s9, s9, s10
    v_lshlrev_b32 v3, 5, v0
    v_add_u32 v3, s9, v3
    v_add_u32 v4, 8192, v3
    v_cmp_gt_u32 vcc, 192, v0
    s_nop 1
    v_cndmask_b32 v4, -1, v4, vcc
    buffer_load_dwordx4 v[96:99], v3, s[52:55], 0 offen sc1
    buffer_load_dwordx4 v[100:103], v4, s[52:55], 0 offen sc1
    s_waitcnt lgkmcnt(0)
    v_readfirstlane_b32 s86, v49
    s_add_u32 m0, s100, 57344
    s_add_u32 s12, s100, 0
    buffer_load_dwordx4 v206, s[68:71], s12 offen offset:0 sc1 lds
    buffer_load_dwordx4 v206, s[68:71], s12 offen offset:1024 sc1 lds
    buffer_load_dwordx4 v206, s[68:71], s12 offen offset:2048 sc1 lds
    buffer_load_dwordx4 v206, s[68:71], s12 offen offset:3072 sc1 lds
    s_add_u32 m0, s100, 61440
    s_add_u32 s12, s100, 4096
    buffer_load_dwordx4 v206, s[68:71], s12 offen offset:0 sc1 lds
    buffer_load_dwordx4 v206, s[68:71], s12 offen offset:1024 sc1 lds
    buffer_load_dwordx4 v206, s[68:71], s12 offen offset:2048 sc1 lds
    v_lshlrev_b32 v3, 2, v0
    s_waitcnt vmcnt(7)
    ds_write_b32 v3, v96 offset:0
    ds_write_b32 v3, v100 offset:1024
    ds_write_b32 v3, v97 offset:2048
    ds_write_b32 v3, v101 offset:3072
    ds_write_b32 v3, v98 offset:4096
    ds_write_b32 v3, v102 offset:5120
    ds_write_b32 v3, v99 offset:6144
    ds_write_b32 v3, v103 offset:7168
    s_waitcnt lgkmcnt(0)
    s_barrier
    v_and_b32 v1, 31, v0
    v_lshrrev_b32 v4, 6, v0
    v_lshlrev_b32 v4, 11, v4
    v_lshl_add_u32 v4, v1, 5, v4
    ds_read_b128 v[96:99], v4 offset:0
    ds_read_b128 v[100:103], v4 offset:16
    ds_read_b128 v[104:107], v4 offset:896
    ds_read_b128 v[108:111], v4 offset:912
    v_bfe_u32 v5, v0, 5, 1
    v_mov_b32 v6, 0x01000c0c
    v_mov_b32 v3, 0x03020c0c
    v_cmp_eq_u32 vcc, 1, v5
    s_nop 1
    v_cndmask_b32 v6, v6, v3, vcc
    s_waitcnt lgkmcnt(0)
    v_perm_b32 v232, v96, v96, v6
    v_perm_b32 v233, v97, v97, v6
    v_perm_b32 v234, v98, v98, v6
    v_perm_b32 v235, v99, v99, v6
    v_perm_b32 v236, v100, v100, v6
    v_perm_b32 v237, v101, v101, v6
    v_perm_b32 v238, v102, v102, v6
    v_perm_b32 v239, v103, v103, v6
    v_perm_b32 v240, v104, v104, v6
    v_perm_b32 v241, v105, v105, v6
    v_perm_b32 v242, v106, v106, v6
    v_perm_b32 v243, v107, v107, v6
    v_perm_b32 v244, v108, v108, v6
    v_perm_b32 v245, v109, v109, v6
    v_perm_b32 v246, v110, v110, v6
    v_perm_b32 v247, v111, v111, v6
    v_mov_b32 v7, 0xffff0000
    s_branch K_gate
K_layer:
    v_pk_add_f32 v[72:73], v[16:17], v[18:19]
    v_pk_add_f32 v[74:75], v[20:21], v[22:23]
    v_pk_add_f32 v[76:77], v[24:25], v[26:27]
    v_pk_add_f32 v[78:79], v[28:29], v[30:31]
    v_pk_add_f32 v[72:73], v[72:73], v[74:75]
    v_pk_add_f32 v[76:77], v[76:77], v[78:79]
    v_pk_add_f32 v[72:73], v[72:73], v[76:77]
    v_add_f32 v80, v72, v73
    v_cndmask_b32 v80, 0, v80, s[88:89]
    s_nop 1
    v_add_f32_dpp v80, v80, v80 quad_perm:[1,0,3,2] row_mask:0xf bank_mask:0xf
    s_nop 1
    v_add_f32_dpp v80, v80, v80 quad_perm:[2,3,0,1] row_mask:0xf bank_mask:0xf
    s_nop 1
    v_add_f32_dpp v80, v80, v80 row_half_mirror row_mask:0xf bank_mask:0xf
    s_nop 1
    v_add_f32_dpp v80, v80, v80 row_mirror row_mask:0xf bank_mask:0xf
    v_mov_b32 v81, v80
    s_nop 1
    v_permlane16_swap_b32 v80, v81
    v_add_f32 v80, v80, v81
    v_mul_f32 v80, 0xbb124925, v80
    v_mov_b32 v81, v80
    v_pk_add_f32 v[32:33], v[16:17], v[80:81]
    v_pk_add_f32 v[34:35], v[18:19], v[80:81]
    v_pk_add_f32 v[36:37], v[20:21], v[80:81]
    v_pk_add_f32 v[38:39], v[22:23], v[80:81]
    v_pk_add_f32 v[40:41], v[24:25], v[80:81]
    v_pk_add_f32 v[42:43], v[26:27], v[80:81]
    v_pk_add_f32 v[44:45], v[28:29], v[80:81]
    v_pk_add_f32 v[46:47], v[30:31], v[80:81]
    v_pk_mul_f32 v[72:73], v[32:33], v[32:33]
    v_pk_mul_f32 v[74:75], v[34:35], v[34:35]
    v_pk_fma_f32 v[72:73], v[36:37], v[36:37], v[72:73]
    v_pk_fma_f32 v[74:75], v[38:39], v[38:39], v[74:75]
    v_pk_fma_f32 v[72:73], v[40:41], v[40:41], v[72:73]
    v_pk_fma_f32 v[74:75], v[42:43], v[42:43], v[74:75]
    v_pk_fma_f32 v[72:73], v[44:45], v[44:45], v[72:73]
    v_pk_fma_f32 v[74:75], v[46:47], v[46:47], v[74:75]
    v_pk_add_f32 v[72:73], v[72:73], v[74:75]
    v_add_f32 v82, v72, v73
    v_cndmask_b32 v82, 0, v82, s[88:89]
    s_nop 1
    v_add_f32_dpp v82, v82, v82 quad_perm:[1,0,3,2] row_mask:0xf bank_mask:0xf
    s_nop 1
    v_add_f32_dpp v82, v82, v82 quad_perm:[2,3,0,1] row_mask:0xf bank_mask:0xf
    s_nop 1
    v_add_f32_dpp v82, v82, v82 row_half_mirror row_mask:0xf bank_mask:0xf
    s_nop 1
    v_add_f32_dpp v82, v82, v82 row_mirror row_mask:0xf bank_mask:0xf
    v_mov_b32 v83, v82
    s_nop 1
    v_permlane16_swap_b32 v82, v83
    v_add_f32 v82, v82, v83
    v_mov_b32 v83, 0x3727c5ac
    v_fmac_f32 v83, 0x3b124925, v82
    v_rsq_f32 v82, v83
    s_nop 0
    v_mov_b32 v83, v82
    v_pk_mul_f32 v[32:33], v[32:33], v[82:83]
    v_pk_mul_f32 v[34:35], v[34:35], v[82:83]
    v_pk_mul_f32 v[36:37], v[36:37], v[82:83]
    v_pk_mul_f32 v[38:39], v[38:39], v[82:83]
    v_pk_mul_f32 v[40:41], v[40:41], v[82:83]
    v_pk_mul_f32 v[42:43], v[42:43], v[82:83]
    v_pk_mul_f32 v[44:45], v[44:45], v[82:83]
    v_pk_mul_f32 v[46:47], v[46:47], v[82:83]
K_gate:
    v_pk_fma_f32 v[16:17], v[32:33], v[232:233], v[16:17]
    v_pk_fma_f32 v[18:19], v[34:35], v[234:235], v[18:19]
    v_pk_fma_f32 v[20:21], v[36:37], v[236:237], v[20:21]
    v_pk_fma_f32 v[22:23], v[38:39], v[238:239], v[22:23]
    v_pk_fma_f32 v[24:25], v[40:41], v[240:241], v[24:25]
    v_pk_fma_f32 v[26:27], v[42:43], v[242:243], v[26:27]
    s_add_u32 m0, s100, 86016
    s_add_u32 s12, s100, 28672
    buffer_load_dwordx4 v206, s[68:71], s12 offen offset:0 sc1 lds
    v_pk_fma_f32 v[28:29], v[44:45], v[244:245], v[28:29]
    v_pk_fma_f32 v[30:31], v[46:47], v[246:247], v[30:31]
    v_pk_add_f32 v[72:73], v[16:17], v[18:19]
    v_pk_add_f32 v[74:75], v[20:21], v[22:23]
    v_pk_add_f32 v[76:77], v[24:25], v[26:27]
    v_pk_add_f32 v[78:79], v[28:29], v[30:31]
    buffer_load_dwordx4 v206, s[68:71], s12 offen offset:1024 sc1 lds
    v_pk_add_f32 v[72:73], v[72:73], v[74:75]
    v_pk_add_f32 v[76:77], v[76:77], v[78:79]
    v_pk_add_f32 v[72:73], v[72:73], v[76:77]
    v_add_f32 v80, v72, v73
    v_cndmask_b32 v80, 0, v80, s[88:89]
    s_nop 1
    v_add_f32_dpp v80, v80, v80 quad_perm:[1,0,3,2] row_mask:0xf bank_mask:0xf
    buffer_load_dwordx4 v206, s[68:71], s12 offen offset:2048 sc1 lds
    s_nop 0
    v_add_f32_dpp v80, v80, v80 quad_perm:[2,3,0,1] row_mask:0xf bank_mask:0xf
    s_nop 1
    v_add_f32_dpp v80, v80, v80 row_half_mirror row_mask:0xf bank_mask:0xf
    s_nop 1
    v_add_f32_dpp v80, v80, v80 row_mirror row_mask:0xf bank_mask:0xf
    v_mov_b32 v81, v80
    s_nop 1
    v_permlane16_swap_b32 v80, v81
    v_add_f32 v80, v80, v81
    buffer_load_dwordx4 v206, s[68:71], s12 offen offset:3072 sc1 lds
    v_mul_f32 v80, 0xbb124925, v80
    v_mov_b32 v81, v80
    v_pk_add_f32 v[32:33], v[16:17], v[80:81]
    v_pk_add_f32 v[34:35], v[18:19], v[80:81]
    v_pk_add_f32 v[36:37], v[20:21], v[80:81]
    v_pk_add_f32 v[38:39], v[22:23], v[80:81]
    s_add_u32 m0, s100, 90112
    s_add_u32 s12, s100, 32768
    buffer_load_dwordx4 v206, s[68:71], s12 offen offset:0 sc1 lds
    v_pk_add_f32 v[40:41], v[24:25], v[80:81]
    v_pk_add_f32 v[42:43], v[26:27], v[80:81]
    v_pk_add_f32 v[44:45], v[28:29], v[80:81]
    v_pk_add_f32 v[46:47], v[30:31], v[80:81]
    v_pk_mul_f32 v[72:73], v[32:33], v[32:33]
    v_pk_mul_f32 v[74:75], v[34:35], v[34:35]
    buffer_load_dwordx4 v206, s[68:71], s12 offen offset:1024 sc1 lds
    v_pk_fma_f32 v[72:73], v[36:37], v[36:37], v[72:73]
    v_pk_fma_f32 v[74:75], v[38:39], v[38:39], v[74:75]
    v_pk_fma_f32 v[72:73], v[40:41], v[40:41], v[72:73]
    v_pk_fma_f32 v[74:75], v[42:43], v[42:43], v[74:75]
    v_pk_fma_f32 v[72:73], v[44:45], v[44:45], v[72:73]
    v_pk_fma_f32 v[74:75], v[46:47], v[46:47], v[74:75]
    buffer_load_dwordx4 v206, s[68:71], s12 offen offset:2048 sc1 lds
    v_pk_add_f32 v[72:73], v[72:73], v[74:75]
    v_add_f32 v82, v72, v73
    v_cndmask_b32 v82, 0, v82, s[88:89]
    s_nop 1
    v_add_f32_dpp v82, v82, v82 quad_perm:[1,0,3,2] row_mask:0xf bank_mask:0xf
    s_nop 1
    v_add_f32_dpp v82, v82, v82 quad_perm:[2,3,0,1] row_mask:0xf bank_mask:0xf
    s_nop 1
    v_add_f32_dpp v82, v82, v82 row_half_mirror row_mask:0xf bank_mask:0xf
    s_nop 1
    v_add_f32_dpp v82, v82, v82 row_mirror row_mask:0xf bank_mask:0xf
    v_mov_b32 v83, v82
    s_nop 1
    v_permlane16_swap_b32 v82, v83
    v_add_f32 v82, v82, v83
    v_mov_b32 v83, 0x3727c5ac
    v_fmac_f32 v83, 0x3b124925, v82
    v_rsq_f32 v82, v83
    s_nop 0
    v_mul_f32 v82, 0x3fb8aa3b, v82
    v_mov_b32 v83, v82
    v_pk_mul_f32 v[32:33], v[32:33], v[82:83]
    v_pk_mul_f32 v[34:35], v[34:35], v[82:83]
    v_pk_mul_f32 v[36:37], v[36:37], v[82:83]
    v_pk_mul_f32 v[38:39], v[38:39], v[82:83]
    v_pk_mul_f32 v[40:41], v[40:41], v[82:83]
    v_pk_mul_f32 v[42:43], v[42:43], v[82:83]
    v_pk_mul_f32 v[44:45], v[44:45], v[82:83]
    v_pk_mul_f32 v[46:47], v[46:47], v[82:83]
    v_cvt_pk_bf16_f32 v64, v32, v33
    v_cvt_pk_bf16_f32 v65, v34, v35
    v_cvt_pk_bf16_f32 v66, v36, v37
    v_cvt_pk_bf16_f32 v67, v38, v39
    v_cvt_pk_bf16_f32 v68, v40, v41
    v_cvt_pk_bf16_f32 v69, v42, v43
    v_cvt_pk_bf16_f32 v70, v44, v45
    v_cvt_pk_bf16_f32 v71, v46, v47
    s_mul_i32 s9, s5, 57344
    v_subrev_u32 v3, s9, v248
    v_subrev_u32 v4, s9, v249
    v_cndmask_b32 v3, -1, v3, s[88:89]
    v_cndmask_b32 v4, -1, v4, s[88:89]
    buffer_store_dwordx4 v[64:67], v3, s[72:75], 0 offen
    buffer_store_dwordx4 v[68:71], v4, s[72:75], 0 offen
    v_cvt_pk_bf16_f32 v224, v16, v17
    v_cvt_pk_bf16_f32 v225, v18, v19
    v_cvt_pk_bf16_f32 v226, v20, v21
    v_cvt_pk_bf16_f32 v227, v22, v23
    v_cvt_pk_bf16_f32 v228, v24, v25
    v_cvt_pk_bf16_f32 v229, v26, v27
    v_cvt_pk_bf16_f32 v230, v28, v29
    v_cvt_pk_bf16_f32 v231, v30, v31
    v_and_b32 v10, 7, v0
    s_lshl_b32 s9, s5, 7
    s_lshl_b32 s10, s87, 13
    s_add_u32 s9, s9, s10
    s_add_u32 s9, s9, 65536
    v_lshl_add_u32 v10, v10, 3, s9
    s_lshl_b32 s10, s6, 3
    s_add_u32 s9, s9, s10
    v_mov_b32 v9, s9
    v_mov_b32 v250, s84
    v_mov_b32 v251, s85
    s_waitcnt vmcnt(0)
    s_barrier
    s_cmp_eq_u32 s3, 0
    s_cbranch_scc0 css_23
    s_mov_b64 exec, 1
    s_cmp_eq_u32 s86, 1
    s_cbranch_scc0 csl_24
    buffer_store_dwordx2 v[250:251], v9, s[64:67], 0 offen
csg_25:
    s_mov_b64 exec, 0xff
    s_mov_b32 s90, 0
csp_26:
    buffer_load_dwordx2 v[2:3], v10, s[64:67], 0 offen sc1
    s_waitcnt vmcnt(0)
    v_cmp_eq_u64 vcc, s[84:85], v[2:3]
    s_add_u32 s90, s90, 1
    s_nop 3
    s_cmp_eq_u64 vcc, exec
    s_cbranch_scc1 csd_27
    s_cmp_lt_u32 s90, 0x100000
    s_cbranch_scc1 csp_26
csd_27:
    s_mov_b64 exec, -1
    s_cmp_eq_u32 s86, 1
    s_cbranch_scc1 css_23
    buffer_inv sc1
    s_waitcnt vmcnt(0)
css_23:
    s_barrier
    s_lshl_b32 s9, s3, 13
    s_mul_i32 s10, s3, 6144
    s_add_u32 m0, s9, 0
    s_nop 0
    buffer_load_dwordx4 v200, s[72:75], s101 offen sc1 lds
    s_add_u32 m0, s9, 1024
    s_nop 0
    buffer_load_dwordx4 v201, s[72:75], s101 offen sc1 lds
    s_add_u32 m0, s9, 2048
    s_nop 0
    buffer_load_dwordx4 v209, s[72:75], s101 offen sc1 lds
    s_add_u32 m0, s9, 3072
    s_nop 0
    buffer_load_dwordx4 v210, s[72:75], s101 offen sc1 lds
    s_add_u32 m0, s9, 4096
    s_nop 0
    buffer_load_dwordx4 v211, s[72:75], s101 offen sc1 lds
    s_add_u32 m0, s9, 5120
    s_nop 0
    buffer_load_dwordx4 v212, s[72:75], s101 offen sc1 lds
    s_add_u32 m0, s9, 6144
    s_nop 0
    buffer_load_dwordx4 v213, s[72:75], s101 offen sc1 lds
    s_add_u32 m0, s9, 7168
    s_nop 0
    buffer_load_dwordx4 v214, s[72:75], s101 offen sc1 lds
    s_add_u32 m0, s10, 32768
    s_nop 0
    buffer_load_dwordx4 v215, s[72:75], s101 offen sc1 lds
    s_add_u32 m0, s10, 33792
    s_nop 0
    buffer_load_dwordx4 v216, s[72:75], s101 offen sc1 lds
    s_add_u32 m0, s10, 34816
    s_nop 0
    buffer_load_dwordx4 v217, s[72:75], s101 offen sc1 lds
    s_add_u32 m0, s10, 35840
    s_nop 0
    buffer_load_dwordx4 v220, s[72:75], s101 offen sc1 lds
    s_add_u32 m0, s10, 36864
    s_nop 0
    buffer_load_dwordx4 v221, s[72:75], s101 offen sc1 lds
    s_add_u32 m0, s10, 37888
    s_nop 0
    buffer_load_dwordx4 v222, s[72:75], s101 offen sc1 lds
    v_and_b32 v1, 63, v0
    v_and_b32 v2, 15, v1
    v_lshrrev_b32 v3, 4, v1
    s_lshl_b32 s9, s8, 5
    v_add_u32 v4, s9, v2
    v_and_b32 v5, 3, v2
    v_xor_b32 v5, v5, v3
    v_lshlrev_b32 v5, 4, v5
    v_lshl_add_u32 v5, v4, 9, v5
    v_lshrrev_b32 v6, 2, v2
    v_xor_b32 v8, 0, v6
    v_lshl_add_u32 v108, v8, 6, v5
    v_xor_b32 v8, 1, v6
    v_lshl_add_u32 v109, v8, 6, v5
    v_xor_b32 v8, 2, v6
    v_lshl_add_u32 v110, v8, 6, v5
    v_xor_b32 v8, 3, v6
    v_lshl_add_u32 v111, v8, 6, v5
    v_and_b32 v5, 2, v2
    v_xor_b32 v5, v5, v3
    v_lshlrev_b32 v5, 4, v5
    v_mul_u32_u24 v4, 384, v4
    v_add_u32 v5, v5, v4
    v_add_u32 v5, 32768, v5
    v_and_b32 v6, 1, v6
    v_lshl_add_u32 v112, v6, 6, v5
    v_xor_b32 v6, 1, v6
    v_lshl_add_u32 v113, v6, 6, v5
    s_lshr_b32 s9, s6, 1
    s_cmp_eq_u32 s9, s3
    s_cselect_b32 s9, 1, 0
    s_and_b32 s10, s6, 1
    s_xor_b32 s11, s10, 1
    s_and_b32 s11, s11, s9
    s_and_b32 s10, s10, s9
    s_lshl_b32 s11, s11, 31
    s_lshl_b32 s10, s10, 31
    s_or_b32 s14, s101, s11
    s_or_b32 s15, s101, s10
    s_lshl_b32 s9, s87, 31
    s_or_b32 s14, s14, s9
    s_or_b32 s15, s15, s9
    s_waitcnt vmcnt(6)
    s_barrier
    ds_read_b128 v[16:19], v202 offset:0
    ds_read_b128 a[196:199], v108 offset:0
    ds_read_b128 a[200:203], v108 offset:8192
    ds_read_b128 v[20:23], v202 offset:1024
    ds_read_b128 a[204:207], v109 offset:0
    ds_read_b128 a[208:211], v109 offset:8192
    ds_read_b128 v[24:27], v202 offset:2048
    ds_read_b128 a[212:215], v110 offset:0
    ds_read_b128 a[216:219], v110 offset:8192
    ds_read_b128 v[28:31], v202 offset:3072
    ds_read_b128 a[220:223], v111 offset:0
    ds_read_b128 a[224:227], v111 offset:8192
    ds_read_b128 v[32:35], v202 offset:4096
    ds_read_b128 a[228:231], v108 offset:256
    ds_read_b128 a[232:235], v108 offset:8448
    ds_read_b128 v[36:39], v202 offset:5120
    ds_read_b128 a[236:239], v109 offset:256
    ds_read_b128 a[240:243], v109 offset:8448
    ds_read_b128 v[40:43], v202 offset:6144
    ds_read_b128 a[244:247], v110 offset:256
    ds_read_b128 a[248:251], v110 offset:8448
    s_waitcnt lgkmcnt(15)
    v_mfma_f32_16x16x32_bf16 v[72:75], v[16:19], a[196:199], 0
    ds_read_b128 v[44:47], v202 offset:7168
    ds_read_b128 a[252:255], v111 offset:256
    v_mfma_f32_16x16x32_bf16 v[76:79], v[16:19], a[200:203], 0
    ds_read_b128 v[48:51], v202 offset:8192
    ds_read_b128 v[148:151], v111 offset:8448
    v_mfma_f32_16x16x32_bf16 v[72:75], v[20:23], a[204:207], v[72:75]
    ds_read_b128 v[52:55], v202 offset:9216
    s_waitcnt vmcnt(0)
    s_barrier
    ds_read_b128 v[152:155], v112 offset:0
    v_mfma_f32_16x16x32_bf16 v[76:79], v[20:23], a[208:211], v[76:79]
    s_add_u32 m0, s100, 114688
    s_add_u32 s12, s100, 57344
    ds_read_b128 v[56:59], v202 offset:10240
    ds_read_b128 v[156:159], v112 offset:6144
    buffer_load_dwordx4 v206, s[68:71], s12 offen offset:0 sc1 lds
    s_waitcnt lgkmcnt(15)
    v_mfma_f32_16x16x32_bf16 v[72:75], v[24:27], a[212:215], v[72:75]
    ds_read_b128 v[60:63], v202 offset:11264
    ds_read_b128 v[160:163], v113 offset:0
    v_mfma_f32_16x16x32_bf16 v[76:79], v[24:27], a[216:219], v[76:79]
    ds_read_b128 v[64:67], v202 offset:12288
    ds_read_b128 v[164:167], v113 offset:6144
    buffer_load_dwordx4 v206, s[68:71], s12 offen offset:1024 sc1 lds
    v_mfma_f32_16x16x32_bf16 v[72:75], v[28:31], a[220:223], v[72:75]
    ds_read_b128 v[68:71], v202 offset:13312
    ds_read_b128 v[168:171], v112 offset:128
    buffer_load_dwordx4 v206, s[68:71], s12 offen offset:2048 sc1 lds
    v_mfma_f32_16x16x32_bf16 v[76:79], v[28:31], a[224:227], v[76:79]
    ds_read_b128 v[172:175], v112 offset:6272
    s_waitcnt lgkmcnt(15)
    v_mfma_f32_16x16x32_bf16 v[72:75], v[32:35], a[228:231], v[72:75]
    ds_read_b128 v[176:179], v113 offset:128
    buffer_load_dwordx4 v206, s[68:71], s12 offen offset:3072 sc1 lds
    v_mfma_f32_16x16x32_bf16 v[76:79], v[32:35], a[232:235], v[76:79]
    s_add_u32 m0, s100, 118784
    s_add_u32 s12, s100, 61440
    ds_read_b128 v[180:183], v113 offset:6272
    buffer_load_dwordx4 v206, s[68:71], s12 offen offset:0 sc1 lds
    v_mfma_f32_16x16x32_bf16 v[72:75], v[36:39], a[236:239], v[72:75]
    ds_read_b128 v[184:187], v112 offset:256
    v_mfma_f32_16x16x32_bf16 v[76:79], v[36:39], a[240:243], v[76:79]
    ds_read_b128 v[188:191], v112 offset:6400
    buffer_load_dwordx4 v206, s[68:71], s12 offen offset:1024 sc1 lds
    v_mfma_f32_16x16x32_bf16 v[72:75], v[40:43], a[244:247], v[72:75]
    ds_read_b128 v[192:195], v113 offset:256
    buffer_load_dwordx4 v206, s[68:71], s12 offen offset:2048 sc1 lds
    v_mfma_f32_16x16x32_bf16 v[76:79], v[40:43], a[248:251], v[76:79]
    ds_read_b128 v[196:199], v113 offset:6400
    s_waitcnt lgkmcnt(8)
    s_waitcnt lgkmcnt(0)
    s_barrier
    v_mfma_f32_16x16x32_bf16 v[72:75], v[44:47], a[252:255], v[72:75]
    ds_read_b128 v[16:19], v202 offset:28672
    v_mfma_f32_16x16x32_bf16 v[76:79], v[44:47], v[148:151], v[76:79]
    s_add_u32 m0, s100, 28672
    s_add_u32 s12, s100, 86016
    ds_read_b128 v[20:23], v202 offset:29696
    buffer_load_dwordx4 v206, s[68:71], s12 offen offset:0 sc1 lds
    v_mfma_f32_16x16x32_bf16 v[72:75], v[48:51], v[152:155], v[72:75]
    ds_read_b128 v[24:27], v202 offset:30720
    v_mfma_f32_16x16x32_bf16 v[76:79], v[48:51], v[156:159], v[76:79]
    ds_read_b128 v[28:31], v202 offset:31744
    v_mfma_f32_16x16x32_bf16 v[72:75], v[52:55], v[160:163], v[72:75]
    ds_read_b128 v[32:35], v202 offset:32768
    buffer_load_dwordx4 v206, s[68:71], s12 offen offset:1024 sc1 lds
    v_mfma_f32_16x16x32_bf16 v[76:79], v[52:55], v[164:167], v[76:79]
    ds_read_b128 v[36:39], v202 offset:33792
    v_mfma_f32_16x16x32_bf16 v[72:75], v[56:59], v[168:171], v[72:75]
    ds_read_b128 v[40:43], v202 offset:34816
    v_mfma_f32_16x16x32_bf16 v[76:79], v[56:59], v[172:175], v[76:79]
    v_mfma_f32_16x16x32_bf16 v[72:75], v[60:63], v[176:179], v[72:75]
    buffer_load_dwordx4 v206, s[68:71], s12 offen offset:2048 sc1 lds
    v_mfma_f32_16x16x32_bf16 v[76:79], v[60:63], v[180:183], v[76:79]
    v_mfma_f32_16x16x32_bf16 v[72:75], v[64:67], v[184:187], v[72:75]
    v_mfma_f32_16x16x32_bf16 v[76:79], v[64:67], v[188:191], v[76:79]
    buffer_load_dwordx4 v206, s[68:71], s12 offen offset:3072 sc1 lds
    v_mfma_f32_16x16x32_bf16 v[72:75], v[68:71], v[192:195], v[72:75]
    v_mfma_f32_16x16x32_bf16 v[76:79], v[68:71], v[196:199], v[76:79]
    s_waitcnt lgkmcnt(0)
    v_mfma_f32_16x16x32_bf16 v[80:83], v[16:19], a[196:199], 0
    ds_read_b128 v[44:47], v202 offset:35840
    v_mfma_f32_16x16x32_bf16 v[84:87], v[16:19], a[200:203], 0
    ds_read_b128 v[48:51], v202 offset:36864
    v_mfma_f32_16x16x32_bf16 v[80:83], v[20:23], a[204:207], v[80:83]
    s_add_u32 m0, s100, 32768
    s_add_u32 s12, s100, 90112
    ds_read_b128 v[52:55], v202 offset:37888
    buffer_load_dwordx4 v206, s[68:71], s12 offen offset:0 sc1 lds
    v_mfma_f32_16x16x32_bf16 v[84:87], v[20:23], a[208:211], v[84:87]
    ds_read_b128 v[56:59], v202 offset:38912
    v_mfma_f32_16x16x32_bf16 v[80:83], v[24:27], a[212:215], v[80:83]
    ds_read_b128 v[60:63], v202 offset:39936
    v_mfma_f32_16x16x32_bf16 v[84:87], v[24:27], a[216:219], v[84:87]
    ds_read_b128 v[64:67], v202 offset:40960
    v_mfma_f32_16x16x32_bf16 v[80:83], v[28:31], a[220:223], v[80:83]
    ds_read_b128 v[68:71], v202 offset:41984
    buffer_load_dwordx4 v206, s[68:71], s12 offen offset:1024 sc1 lds
    v_mfma_f32_16x16x32_bf16 v[84:87], v[28:31], a[224:227], v[84:87]
    v_exp_f32_e64 v96, -v72
    v_mfma_f32_16x16x32_bf16 v[80:83], v[32:35], a[228:231], v[80:83]
    v_exp_f32_e64 v97, -v73
    v_mfma_f32_16x16x32_bf16 v[84:87], v[32:35], a[232:235], v[84:87]
    v_exp_f32_e64 v98, -v74
    v_mfma_f32_16x16x32_bf16 v[80:83], v[36:39], a[236:239], v[80:83]
    buffer_load_dwordx4 v206, s[68:71], s12 offen offset:2048 sc1 lds
    v_exp_f32_e64 v99, -v75
    v_mfma_f32_16x16x32_bf16 v[84:87], v[36:39], a[240:243], v[84:87]
    v_exp_f32_e64 v100, -v76
    v_mfma_f32_16x16x32_bf16 v[80:83], v[40:43], a[244:247], v[80:83]
    v_exp_f32_e64 v101, -v77
    v_mfma_f32_16x16x32_bf16 v[84:87], v[40:43], a[248:251], v[84:87]
    s_waitcnt lgkmcnt(0)
    s_waitcnt vmcnt(7)
    v_exp_f32_e64 v102, -v78
    v_exp_f32_e64 v103, -v79
    s_barrier
    v_mfma_f32_16x16x32_bf16 v[80:83], v[44:47], a[252:255], v[80:83]
    ds_read_b128 v[16:19], v203 offset:0
    v_add_f32 v96, 1.0, v96
    v_mfma_f32_16x16x32_bf16 v[84:87], v[44:47], v[148:151], v[84:87]
    s_add_u32 m0, s100, 57344
    s_add_u32 s12, s100, 114688
    ds_read_b128 v[20:23], v203 offset:1024
    buffer_load_dwordx4 v206, s[68:71], s12 offen offset:0 sc1 lds
    v_add_f32 v97, 1.0, v97
    v_mfma_f32_16x16x32_bf16 v[80:83], v[48:51], v[152:155], v[80:83]
    ds_read_b128 v[24:27], v203 offset:2048
    v_add_f32 v98, 1.0, v98
    v_mfma_f32_16x16x32_bf16 v[84:87], v[48:51], v[156:159], v[84:87]
    ds_read_b128 v[28:31], v203 offset:3072
    v_add_f32 v99, 1.0, v99
    v_mfma_f32_16x16x32_bf16 v[80:83], v[52:55], v[160:163], v[80:83]
    ds_read_b128 v[32:35], v203 offset:4096
    buffer_load_dwordx4 v206, s[68:71], s12 offen offset:1024 sc1 lds
    v_add_f32 v100, 1.0, v100
    v_mfma_f32_16x16x32_bf16 v[84:87], v[52:55], v[164:167], v[84:87]
    ds_read_b128 v[36:39], v203 offset:5120
    v_add_f32 v101, 1.0, v101
    v_mfma_f32_16x16x32_bf16 v[80:83], v[56:59], v[168:171], v[80:83]
    ds_read_b128 v[40:43], v203 offset:6144
    v_add_f32 v102, 1.0, v102
    v_add_f32 v103, 1.0, v103
    v_mfma_f32_16x16x32_bf16 v[84:87], v[56:59], v[172:175], v[84:87]
    v_rcp_f32 v96, v96
    v_mfma_f32_16x16x32_bf16 v[80:83], v[60:63], v[176:179], v[80:83]
    buffer_load_dwordx4 v206, s[68:71], s12 offen offset:2048 sc1 lds
    v_rcp_f32 v97, v97
    v_mfma_f32_16x16x32_bf16 v[84:87], v[60:63], v[180:183], v[84:87]
    v_rcp_f32 v98, v98
    v_mfma_f32_16x16x32_bf16 v[80:83], v[64:67], v[184:187], v[80:83]
    v_rcp_f32 v99, v99
    v_mfma_f32_16x16x32_bf16 v[84:87], v[64:67], v[188:191], v[84:87]
    buffer_load_dwordx4 v206, s[68:71], s12 offen offset:3072 sc1 lds
    v_rcp_f32 v100, v100
    v_mfma_f32_16x16x32_bf16 v[80:83], v[68:71], v[192:195], v[80:83]
    v_rcp_f32 v101, v101
    v_mfma_f32_16x16x32_bf16 v[84:87], v[68:71], v[196:199], v[84:87]
    s_waitcnt lgkmcnt(0)
    v_rcp_f32 v102, v102
    v_rcp_f32 v103, v103
    v_mfma_f32_16x16x32_bf16 v[88:91], v[16:19], a[196:199], 0
    ds_read_b128 v[44:47], v203 offset:7168
    v_mul_f32 v96, v72, v96
    v_mul_f32 v97, v73, v97
    v_mfma_f32_16x16x32_bf16 v[92:95], v[16:19], a[200:203], 0
    ds_read_b128 v[48:51], v203 offset:8192
    v_mul_f32 v98, v74, v98
    v_mul_f32 v99, v75, v99
    v_mfma_f32_16x16x32_bf16 v[88:91], v[20:23], a[204:207], v[88:91]
    s_add_u32 m0, s100, 61440
    s_add_u32 s12, s100, 118784
    ds_read_b128 v[52:55], v203 offset:9216
    buffer_load_dwordx4 v206, s[68:71], s12 offen offset:0 sc1 lds
    v_mul_f32 v100, v76, v100
    v_mul_f32 v101, v77, v101
    v_mfma_f32_16x16x32_bf16 v[92:95], v[20:23], a[208:211], v[92:95]
    ds_read_b128 v[56:59], v203 offset:10240
    v_mul_f32 v102, v78, v102
    v_mul_f32 v103, v79, v103
    v_mfma_f32_16x16x32_bf16 v[88:91], v[24:27], a[212:215], v[88:91]
    ds_read_b128 v[60:63], v203 offset:11264
    v_cvt_pk_bf16_f32 v104, v96, v97
    v_cvt_pk_bf16_f32 v105, v98, v99
    v_mfma_f32_16x16x32_bf16 v[92:95], v[24:27], a[216:219], v[92:95]
    ds_read_b128 v[64:67], v203 offset:12288
    v_cvt_pk_bf16_f32 v106, v100, v101
    v_mfma_f32_16x16x32_bf16 v[88:91], v[28:31], a[220:223], v[88:91]
    ds_read_b128 v[68:71], v203 offset:13312
    buffer_load_dwordx4 v206, s[68:71], s12 offen offset:1024 sc1 lds
    v_cvt_pk_bf16_f32 v107, v102, v103
    v_mfma_f32_16x16x32_bf16 v[92:95], v[28:31], a[224:227], v[92:95]
    ds_write_b64 v204, v[104:105] offset:0
    v_exp_f32_e64 v96, -v80
    v_mfma_f32_16x16x32_bf16 v[88:91], v[32:35], a[228:231], v[88:91]
    v_exp_f32_e64 v97, -v81
    v_mfma_f32_16x16x32_bf16 v[92:95], v[32:35], a[232:235], v[92:95]
    ds_write_b64 v204, v[106:107] offset:7168
    v_exp_f32_e64 v98, -v82
    v_mfma_f32_16x16x32_bf16 v[88:91], v[36:39], a[236:239], v[88:91]
    buffer_load_dwordx4 v206, s[68:71], s12 offen offset:2048 sc1 lds
    v_exp_f32_e64 v99, -v83
    v_mfma_f32_16x16x32_bf16 v[92:95], v[36:39], a[240:243], v[92:95]
    v_exp_f32_e64 v100, -v84
    v_mfma_f32_16x16x32_bf16 v[88:91], v[40:43], a[244:247], v[88:91]
    v_exp_f32_e64 v101, -v85
    v_mfma_f32_16x16x32_bf16 v[92:95], v[40:43], a[248:251], v[92:95]
    s_waitcnt lgkmcnt(2)
    s_waitcnt vmcnt(7)
    v_exp_f32_e64 v102, -v86
    v_exp_f32_e64 v103, -v87
    s_barrier
    v_mfma_f32_16x16x32_bf16 v[88:91], v[44:47], a[252:255], v[88:91]
    ds_read_b128 v[16:19], v219 offset:0
    v_add_f32 v96, 1.0, v96
    v_mfma_f32_16x16x32_bf16 v[92:95], v[44:47], v[148:151], v[92:95]
    s_add_u32 m0, s100, 86016
    s_add_u32 s12, s100, 143360
    ds_read_b128 v[20:23], v219 offset:1024
    buffer_load_dwordx4 v206, s[68:71], s12 offen offset:0 sc1 lds
    v_add_f32 v97, 1.0, v97
    v_mfma_f32_16x16x32_bf16 v[88:91], v[48:51], v[152:155], v[88:91]
    ds_read_b128 v[24:27], v219 offset:2048
    v_add_f32 v98, 1.0, v98
    v_mfma_f32_16x16x32_bf16 v[92:95], v[48:51], v[156:159], v[92:95]
    ds_read_b128 v[28:31], v219 offset:3072
    v_add_f32 v99, 1.0, v99
    v_mfma_f32_16x16x32_bf16 v[88:91], v[52:55], v[160:163], v[88:91]
    ds_read_b128 v[32:35], v219 offset:4096
    buffer_load_dwordx4 v206, s[68:71], s12 offen offset:1024 sc1 lds
    v_add_f32 v100, 1.0, v100
    v_mfma_f32_16x16x32_bf16 v[92:95], v[52:55], v[164:167], v[92:95]
    ds_read_b128 v[36:39], v219 offset:5120
    v_add_f32 v101, 1.0, v101
    v_mfma_f32_16x16x32_bf16 v[88:91], v[56:59], v[168:171], v[88:91]
    ds_read_b128 v[40:43], v219 offset:6144
    v_add_f32 v102, 1.0, v102
    v_add_f32 v103, 1.0, v103
    v_mfma_f32_16x16x32_bf16 v[92:95], v[56:59], v[172:175], v[92:95]
    v_rcp_f32 v96, v96
    v_mfma_f32_16x16x32_bf16 v[88:91], v[60:63], v[176:179], v[88:91]
    buffer_load_dwordx4 v206, s[68:71], s12 offen offset:2048 sc1 lds
    v_rcp_f32 v97, v97
    v_mfma_f32_16x16x32_bf16 v[92:95], v[60:63], v[180:183], v[92:95]
    v_rcp_f32 v98, v98
    v_mfma_f32_16x16x32_bf16 v[88:91], v[64:67], v[184:187], v[88:91]
    v_rcp_f32 v99, v99
    v_mfma_f32_16x16x32_bf16 v[92:95], v[64:67], v[188:191], v[92:95]
    buffer_load_dwordx4 v206, s[68:71], s12 offen offset:3072 sc1 lds
    v_rcp_f32 v100, v100
    v_mfma_f32_16x16x32_bf16 v[88:91], v[68:71], v[192:195], v[88:91]
    v_rcp_f32 v101, v101
    v_mfma_f32_16x16x32_bf16 v[92:95], v[68:71], v[196:199], v[92:95]
    s_waitcnt lgkmcnt(0)
    v_rcp_f32 v102, v102
    v_rcp_f32 v103, v103
    v_mfma_f32_16x16x32_bf16 v[72:75], v[16:19], a[196:199], 0
    ds_read_b128 v[44:47], v219 offset:7168
    v_mul_f32 v96, v80, v96
    v_mul_f32 v97, v81, v97
    v_mfma_f32_16x16x32_bf16 v[76:79], v[16:19], a[200:203], 0
    ds_read_b128 v[48:51], v219 offset:8192
    v_mul_f32 v98, v82, v98
    v_mul_f32 v99, v83, v99
    v_mfma_f32_16x16x32_bf16 v[72:75], v[20:23], a[204:207], v[72:75]
    s_add_u32 m0, s100, 90112
    s_add_u32 s12, s100, 147456
    ds_read_b128 v[52:55], v219 offset:9216
    buffer_load_dwordx4 v206, s[68:71], s12 offen offset:0 sc1 lds
    v_mul_f32 v100, v84, v100
    v_mul_f32 v101, v85, v101
    v_mfma_f32_16x16x32_bf16 v[76:79], v[20:23], a[208:211], v[76:79]
    ds_read_b128 v[56:59], v219 offset:10240
    v_mul_f32 v102, v86, v102
    v_mul_f32 v103, v87, v103
    v_mfma_f32_16x16x32_bf16 v[72:75], v[24:27], a[212:215], v[72:75]
    ds_read_b128 v[60:63], v219 offset:11264
    v_cvt_pk_bf16_f32 v104, v96, v97
    v_cvt_pk_bf16_f32 v105, v98, v99
    v_mfma_f32_16x16x32_bf16 v[76:79], v[24:27], a[216:219], v[76:79]
    ds_read_b128 v[64:67], v219 offset:12288
    v_cvt_pk_bf16_f32 v106, v100, v101
    v_mfma_f32_16x16x32_bf16 v[72:75], v[28:31], a[220:223], v[72:75]
    ds_read_b128 v[68:71], v219 offset:13312
    buffer_load_dwordx4 v206, s[68:71], s12 offen offset:1024 sc1 lds
    v_cvt_pk_bf16_f32 v107, v102, v103
    v_mfma_f32_16x16x32_bf16 v[76:79], v[28:31], a[224:227], v[76:79]
    ds_write_b64 v218, v[104:105] offset:0
    v_exp_f32_e64 v96, -v88
    v_mfma_f32_16x16x32_bf16 v[72:75], v[32:35], a[228:231], v[72:75]
    v_exp_f32_e64 v97, -v89
    v_mfma_f32_16x16x32_bf16 v[76:79], v[32:35], a[232:235], v[76:79]
    ds_write_b64 v218, v[106:107] offset:7168
    v_exp_f32_e64 v98, -v90
    v_mfma_f32_16x16x32_bf16 v[72:75], v[36:39], a[236:239], v[72:75]
    buffer_load_dwordx4 v206, s[68:71], s12 offen offset:2048 sc1 lds
    v_exp_f32_e64 v99, -v91
    v_mfma_f32_16x16x32_bf16 v[76:79], v[36:39], a[240:243], v[76:79]
    v_exp_f32_e64 v100, -v92
    v_mfma_f32_16x16x32_bf16 v[72:75], v[40:43], a[244:247], v[72:75]
    v_exp_f32_e64 v101, -v93
    v_mfma_f32_16x16x32_bf16 v[76:79], v[40:43], a[248:251], v[76:79]
    s_waitcnt lgkmcnt(2)
    s_waitcnt vmcnt(7)
    v_exp_f32_e64 v102, -v94
    v_exp_f32_e64 v103, -v95
    s_barrier
    v_mfma_f32_16x16x32_bf16 v[72:75], v[44:47], a[252:255], v[72:75]
    ds_read_b128 v[16:19], v202 offset:0
    v_add_f32 v96, 1.0, v96
    v_mfma_f32_16x16x32_bf16 v[76:79], v[44:47], v[148:151], v[76:79]
    s_add_u32 m0, s100, 114688
    s_add_u32 s12, s100, 172032
    ds_read_b128 v[20:23], v202 offset:1024
    buffer_load_dwordx4 v206, s[68:71], s12 offen offset:0 sc1 lds
    v_add_f32 v97, 1.0, v97
    v_mfma_f32_16x16x32_bf16 v[72:75], v[48:51], v[152:155], v[72:75]
    ds_read_b128 v[24:27], v202 offset:2048
    v_add_f32 v98, 1.0, v98
    v_mfma_f32_16x16x32_bf16 v[76:79], v[48:51], v[156:159], v[76:79]
    ds_read_b128 v[28:31], v202 offset:3072
    v_add_f32 v99, 1.0, v99
    v_mfma_f32_16x16x32_bf16 v[72:75], v[52:55], v[160:163], v[72:75]
    ds_read_b128 v[32:35], v202 offset:4096
    buffer_load_dwordx4 v206, s[68:71], s12 offen offset:1024 sc1 lds
    v_add_f32 v100, 1.0, v100
    v_mfma_f32_16x16x32_bf16 v[76:79], v[52:55], v[164:167], v[76:79]
    ds_read_b128 v[36:39], v202 offset:5120
    v_add_f32 v101, 1.0, v101
    v_mfma_f32_16x16x32_bf16 v[72:75], v[56:59], v[168:171], v[72:75]
    ds_read_b128 v[40:43], v202 offset:6144
    v_add_f32 v102, 1.0, v102
    v_add_f32 v103, 1.0, v103
    v_mfma_f32_16x16x32_bf16 v[76:79], v[56:59], v[172:175], v[76:79]
    v_rcp_f32 v96, v96
    v_mfma_f32_16x16x32_bf16 v[72:75], v[60:63], v[176:179], v[72:75]
    buffer_load_dwordx4 v206, s[68:71], s12 offen offset:2048 sc1 lds
    v_rcp_f32 v97, v97
    v_mfma_f32_16x16x32_bf16 v[76:79], v[60:63], v[180:183], v[76:79]
    v_rcp_f32 v98, v98
    v_mfma_f32_16x16x32_bf16 v[72:75], v[64:67], v[184:187], v[72:75]
    v_rcp_f32 v99, v99
    v_mfma_f32_16x16x32_bf16 v[76:79], v[64:67], v[188:191], v[76:79]
    buffer_load_dwordx4 v206, s[68:71], s12 offen offset:3072 sc1 lds
    v_rcp_f32 v100, v100
    v_mfma_f32_16x16x32_bf16 v[72:75], v[68:71], v[192:195], v[72:75]
    v_rcp_f32 v101, v101
    v_mfma_f32_16x16x32_bf16 v[76:79], v[68:71], v[196:199], v[76:79]
    s_waitcnt lgkmcnt(0)
    v_rcp_f32 v102, v102
    v_rcp_f32 v103, v103
    v_mfma_f32_16x16x32_bf16 v[80:83], v[16:19], a[196:199], 0
    ds_read_b128 v[44:47], v202 offset:7168
    v_mul_f32 v96, v88, v96
    v_mul_f32 v97, v89, v97
    v_mfma_f32_16x16x32_bf16 v[84:87], v[16:19], a[200:203], 0
    ds_read_b128 v[48:51], v202 offset:8192
    v_mul_f32 v98, v90, v98
    v_mul_f32 v99, v91, v99
    v_mfma_f32_16x16x32_bf16 v[80:83], v[20:23], a[204:207], v[80:83]
    s_add_u32 m0, s100, 118784
    s_add_u32 s12, s100, 176128
    ds_read_b128 v[52:55], v202 offset:9216
    buffer_load_dwordx4 v206, s[68:71], s12 offen offset:0 sc1 lds
    v_mul_f32 v100, v92, v100
    v_mul_f32 v101, v93, v101
    v_mfma_f32_16x16x32_bf16 v[84:87], v[20:23], a[208:211], v[84:87]
    ds_read_b128 v[56:59], v202 offset:10240
    v_mul_f32 v102, v94, v102
    v_mul_f32 v103, v95, v103
    v_mfma_f32_16x16x32_bf16 v[80:83], v[24:27], a[212:215], v[80:83]
    ds_read_b128 v[60:63], v202 offset:11264
    v_cvt_pk_bf16_f32 v104, v96, v97
    v_cvt_pk_bf16_f32 v105, v98, v99
    v_mfma_f32_16x16x32_bf16 v[84:87], v[24:27], a[216:219], v[84:87]
    ds_read_b128 v[64:67], v202 offset:12288
    v_cvt_pk_bf16_f32 v106, v100, v101
    v_mfma_f32_16x16x32_bf16 v[80:83], v[28:31], a[220:223], v[80:83]
    ds_read_b128 v[68:71], v202 offset:13312
    buffer_load_dwordx4 v206, s[68:71], s12 offen offset:1024 sc1 lds
    v_cvt_pk_bf16_f32 v107, v102, v103
    v_mfma_f32_16x16x32_bf16 v[84:87], v[28:31], a[224:227], v[84:87]
    ds_write_b64 v204, v[104:105] offset:64
    v_exp_f32_e64 v96, -v72
    v_mfma_f32_16x16x32_bf16 v[80:83], v[32:35], a[228:231], v[80:83]
    v_exp_f32_e64 v97, -v73
    v_mfma_f32_16x16x32_bf16 v[84:87], v[32:35], a[232:235], v[84:87]
    ds_write_b64 v204, v[106:107] offset:7232
    v_exp_f32_e64 v98, -v74
    v_mfma_f32_16x16x32_bf16 v[80:83], v[36:39], a[236:239], v[80:83]
    buffer_load_dwordx4 v206, s[68:71], s12 offen offset:2048 sc1 lds
    v_exp_f32_e64 v99, -v75
    v_mfma_f32_16x16x32_bf16 v[84:87], v[36:39], a[240:243], v[84:87]
    v_exp_f32_e64 v100, -v76
    v_mfma_f32_16x16x32_bf16 v[80:83], v[40:43], a[244:247], v[80:83]
    v_exp_f32_e64 v101, -v77
    v_mfma_f32_16x16x32_bf16 v[84:87], v[40:43], a[248:251], v[84:87]
    s_waitcnt lgkmcnt(2)
    s_waitcnt vmcnt(7)
    v_exp_f32_e64 v102, -v78
    v_exp_f32_e64 v103, -v79
    s_barrier
    v_mfma_f32_16x16x32_bf16 v[80:83], v[44:47], a[252:255], v[80:83]
    ds_read_b128 v[16:19], v202 offset:28672
    v_add_f32 v96, 1.0, v96
    v_mfma_f32_16x16x32_bf16 v[84:87], v[44:47], v[148:151], v[84:87]
    s_add_u32 s12, s14, 0
    ds_read_b128 v[20:23], v202 offset:29696
    buffer_load_dwordx4 v[124:127], v206, s[76:79], s12 offen
    v_add_f32 v97, 1.0, v97
    v_mfma_f32_16x16x32_bf16 v[80:83], v[48:51], v[152:155], v[80:83]
    ds_read_b128 v[24:27], v202 offset:30720
    v_add_f32 v98, 1.0, v98
    v_mfma_f32_16x16x32_bf16 v[84:87], v[48:51], v[156:159], v[84:87]
    ds_read_b128 v[28:31], v202 offset:31744
    v_add_f32 v99, 1.0, v99
    v_mfma_f32_16x16x32_bf16 v[80:83], v[52:55], v[160:163], v[80:83]
    ds_read_b128 v[32:35], v202 offset:32768
    v_add_f32 v100, 1.0, v100
    v_mfma_f32_16x16x32_bf16 v[84:87], v[52:55], v[164:167], v[84:87]
    s_add_u32 s12, s14, 1024
    ds_read_b128 v[36:39], v202 offset:33792
    buffer_load_dwordx4 v[124:127], v206, s[76:79], s12 offen
    v_add_f32 v101, 1.0, v101
    v_mfma_f32_16x16x32_bf16 v[80:83], v[56:59], v[168:171], v[80:83]
    ds_read_b128 v[40:43], v202 offset:34816
    v_add_f32 v102, 1.0, v102
    v_add_f32 v103, 1.0, v103
    v_mfma_f32_16x16x32_bf16 v[84:87], v[56:59], v[172:175], v[84:87]
    v_rcp_f32 v96, v96
    v_mfma_f32_16x16x32_bf16 v[80:83], v[60:63], v[176:179], v[80:83]
    v_rcp_f32 v97, v97
    v_mfma_f32_16x16x32_bf16 v[84:87], v[60:63], v[180:183], v[84:87]
    s_add_u32 s12, s14, 2048
    buffer_load_dwordx4 v[124:127], v206, s[76:79], s12 offen
    v_rcp_f32 v98, v98
    v_mfma_f32_16x16x32_bf16 v[80:83], v[64:67], v[184:187], v[80:83]
    v_rcp_f32 v99, v99
    v_mfma_f32_16x16x32_bf16 v[84:87], v[64:67], v[188:191], v[84:87]
    v_rcp_f32 v100, v100
    v_mfma_f32_16x16x32_bf16 v[80:83], v[68:71], v[192:195], v[80:83]
    v_rcp_f32 v101, v101
    v_mfma_f32_16x16x32_bf16 v[84:87], v[68:71], v[196:199], v[84:87]
    s_waitcnt lgkmcnt(0)
    v_rcp_f32 v102, v102
    v_rcp_f32 v103, v103
    v_mfma_f32_16x16x32_bf16 v[88:91], v[16:19], a[196:199], 0
    ds_read_b128 v[44:47], v202 offset:35840
    v_mul_f32 v96, v72, v96
    v_mul_f32 v97, v73, v97
    v_mfma_f32_16x16x32_bf16 v[92:95], v[16:19], a[200:203], 0
    s_add_u32 s12, s14, 3072
    ds_read_b128 v[48:51], v202 offset:36864
    buffer_load_dwordx4 v[124:127], v206, s[76:79], s12 offen
    v_mul_f32 v98, v74, v98
    v_mul_f32 v99, v75, v99
    v_mfma_f32_16x16x32_bf16 v[88:91], v[20:23], a[204:207], v[88:91]
    ds_read_b128 v[52:55], v202 offset:37888
    v_mul_f32 v100, v76, v100
    v_mul_f32 v101, v77, v101
    v_mfma_f32_16x16x32_bf16 v[92:95], v[20:23], a[208:211], v[92:95]
    ds_read_b128 v[56:59], v202 offset:38912
    v_mul_f32 v102, v78, v102
    v_mul_f32 v103, v79, v103
    v_mfma_f32_16x16x32_bf16 v[88:91], v[24:27], a[212:215], v[88:91]
    ds_read_b128 v[60:63], v202 offset:39936
    v_cvt_pk_bf16_f32 v104, v96, v97
    v_cvt_pk_bf16_f32 v105, v98, v99
    v_mfma_f32_16x16x32_bf16 v[92:95], v[24:27], a[216:219], v[92:95]
    s_add_u32 s12, s14, 4096
    ds_read_b128 v[64:67], v202 offset:40960
    buffer_load_dwordx4 v[124:127], v206, s[76:79], s12 offen
    v_cvt_pk_bf16_f32 v106, v100, v101
    v_mfma_f32_16x16x32_bf16 v[88:91], v[28:31], a[220:223], v[88:91]
    ds_read_b128 v[68:71], v202 offset:41984
    v_cvt_pk_bf16_f32 v107, v102, v103
    v_mfma_f32_16x16x32_bf16 v[92:95], v[28:31], a[224:227], v[92:95]
    ds_write_b64 v218, v[104:105] offset:64
    v_exp_f32_e64 v96, -v80
    v_mfma_f32_16x16x32_bf16 v[88:91], v[32:35], a[228:231], v[88:91]
    v_exp_f32_e64 v97, -v81
    v_mfma_f32_16x16x32_bf16 v[92:95], v[32:35], a[232:235], v[92:95]
    s_add_u32 s12, s14, 5120
    buffer_load_dwordx4 v[124:127], v206, s[76:79], s12 offen
    ds_write_b64 v218, v[106:107] offset:7232
    v_exp_f32_e64 v98, -v82
    v_mfma_f32_16x16x32_bf16 v[88:91], v[36:39], a[236:239], v[88:91]
    v_exp_f32_e64 v99, -v83
    v_mfma_f32_16x16x32_bf16 v[92:95], v[36:39], a[240:243], v[92:95]
    v_exp_f32_e64 v100, -v84
    v_mfma_f32_16x16x32_bf16 v[88:91], v[40:43], a[244:247], v[88:91]
    v_exp_f32_e64 v101, -v85
    v_mfma_f32_16x16x32_bf16 v[92:95], v[40:43], a[248:251], v[92:95]
    s_waitcnt lgkmcnt(2)
    s_waitcnt vmcnt(6)
    v_exp_f32_e64 v102, -v86
    v_exp_f32_e64 v103, -v87
    s_barrier
    v_mfma_f32_16x16x32_bf16 v[88:91], v[44:47], a[252:255], v[88:91]
    ds_read_b128 v[16:19], v203 offset:0
    v_add_f32 v96, 1.0, v96
    v_mfma_f32_16x16x32_bf16 v[92:95], v[44:47], v[148:151], v[92:95]
    s_add_u32 s12, s14, 6144
    ds_read_b128 v[20:23], v203 offset:1024
    buffer_load_dwordx4 v[124:127], v206, s[76:79], s12 offen
    v_add_f32 v97, 1.0, v97
    v_mfma_f32_16x16x32_bf16 v[88:91], v[48:51], v[152:155], v[88:91]
    ds_read_b128 v[24:27], v203 offset:2048
    v_add_f32 v98, 1.0, v98
    v_mfma_f32_16x16x32_bf16 v[92:95], v[48:51], v[156:159], v[92:95]
    ds_read_b128 v[28:31], v203 offset:3072
    v_add_f32 v99, 1.0, v99
    v_mfma_f32_16x16x32_bf16 v[88:91], v[52:55], v[160:163], v[88:91]
    ds_read_b128 v[32:35], v203 offset:4096
    v_add_f32 v100, 1.0, v100
    v_mfma_f32_16x16x32_bf16 v[92:95], v[52:55], v[164:167], v[92:95]
    s_add_u32 s12, s15, 7168
    ds_read_b128 v[36:39], v203 offset:5120
    buffer_load_dwordx4 v[124:127], v206, s[76:79], s12 offen
    v_add_f32 v101, 1.0, v101
    v_mfma_f32_16x16x32_bf16 v[88:91], v[56:59], v[168:171], v[88:91]
    ds_read_b128 v[40:43], v203 offset:6144
    v_add_f32 v102, 1.0, v102
    v_add_f32 v103, 1.0, v103
    v_mfma_f32_16x16x32_bf16 v[92:95], v[56:59], v[172:175], v[92:95]
    v_rcp_f32 v96, v96
    v_mfma_f32_16x16x32_bf16 v[88:91], v[60:63], v[176:179], v[88:91]
    v_rcp_f32 v97, v97
    v_mfma_f32_16x16x32_bf16 v[92:95], v[60:63], v[180:183], v[92:95]
    s_add_u32 s12, s15, 8192
    buffer_load_dwordx4 v[124:127], v206, s[76:79], s12 offen
    v_rcp_f32 v98, v98
    v_mfma_f32_16x16x32_bf16 v[88:91], v[64:67], v[184:187], v[88:91]
    v_rcp_f32 v99, v99
    v_mfma_f32_16x16x32_bf16 v[92:95], v[64:67], v[188:191], v[92:95]
    v_rcp_f32 v100, v100
    v_mfma_f32_16x16x32_bf16 v[88:91], v[68:71], v[192:195], v[88:91]
    v_rcp_f32 v101, v101
    v_mfma_f32_16x16x32_bf16 v[92:95], v[68:71], v[196:199], v[92:95]
    s_waitcnt lgkmcnt(0)
    v_rcp_f32 v102, v102
    v_rcp_f32 v103, v103
    v_mfma_f32_16x16x32_bf16 v[72:75], v[16:19], a[196:199], 0
    ds_read_b128 v[44:47], v203 offset:7168
    v_mul_f32 v96, v80, v96
    v_mul_f32 v97, v81, v97
    v_mfma_f32_16x16x32_bf16 v[76:79], v[16:19], a[200:203], 0
    s_add_u32 s12, s15, 9216
    ds_read_b128 v[48:51], v203 offset:8192
    buffer_load_dwordx4 v[124:127], v206, s[76:79], s12 offen
    v_mul_f32 v98, v82, v98
    v_mul_f32 v99, v83, v99
    v_mfma_f32_16x16x32_bf16 v[72:75], v[20:23], a[204:207], v[72:75]
    ds_read_b128 v[52:55], v203 offset:9216
    v_mul_f32 v100, v84, v100
    v_mul_f32 v101, v85, v101
    v_mfma_f32_16x16x32_bf16 v[76:79], v[20:23], a[208:211], v[76:79]
    ds_read_b128 v[56:59], v203 offset:10240
    v_mul_f32 v102, v86, v102
    v_mul_f32 v103, v87, v103
    v_mfma_f32_16x16x32_bf16 v[72:75], v[24:27], a[212:215], v[72:75]
    ds_read_b128 v[60:63], v203 offset:11264
    v_cvt_pk_bf16_f32 v104, v96, v97
    v_cvt_pk_bf16_f32 v105, v98, v99
    v_mfma_f32_16x16x32_bf16 v[76:79], v[24:27], a[216:219], v[76:79]
    s_add_u32 s12, s15, 10240
    ds_read_b128 v[64:67], v203 offset:12288
    buffer_load_dwordx4 v[124:127], v206, s[76:79], s12 offen
    v_cvt_pk_bf16_f32 v106, v100, v101
    v_mfma_f32_16x16x32_bf16 v[72:75], v[28:31], a[220:223], v[72:75]
    ds_read_b128 v[68:71], v203 offset:13312
    v_cvt_pk_bf16_f32 v107, v102, v103
    v_mfma_f32_16x16x32_bf16 v[76:79], v[28:31], a[224:227], v[76:79]
    ds_write_b64 v204, v[104:105] offset:128
    v_exp_f32_e64 v96, -v88
    v_mfma_f32_16x16x32_bf16 v[72:75], v[32:35], a[228:231], v[72:75]
    v_exp_f32_e64 v97, -v89
    v_mfma_f32_16x16x32_bf16 v[76:79], v[32:35], a[232:235], v[76:79]
    s_add_u32 s12, s15, 11264
    buffer_load_dwordx4 v[124:127], v206, s[76:79], s12 offen
    ds_write_b64 v204, v[106:107] offset:7296
    v_exp_f32_e64 v98, -v90
    v_mfma_f32_16x16x32_bf16 v[72:75], v[36:39], a[236:239], v[72:75]
    v_exp_f32_e64 v99, -v91
    v_mfma_f32_16x16x32_bf16 v[76:79], v[36:39], a[240:243], v[76:79]
    v_exp_f32_e64 v100, -v92
    v_mfma_f32_16x16x32_bf16 v[72:75], v[40:43], a[244:247], v[72:75]
    v_exp_f32_e64 v101, -v93
    v_mfma_f32_16x16x32_bf16 v[76:79], v[40:43], a[248:251], v[76:79]
    s_waitcnt lgkmcnt(2)
    v_exp_f32_e64 v102, -v94
    v_exp_f32_e64 v103, -v95
    s_barrier
    v_mfma_f32_16x16x32_bf16 v[72:75], v[44:47], a[252:255], v[72:75]
    v_add_f32 v96, 1.0, v96
    v_mfma_f32_16x16x32_bf16 v[76:79], v[44:47], v[148:151], v[76:79]
    s_add_u32 s12, s15, 12288
    buffer_load_dwordx4 v[124:127], v206, s[76:79], s12 offen
    v_add_f32 v97, 1.0, v97
    v_mfma_f32_16x16x32_bf16 v[72:75], v[48:51], v[152:155], v[72:75]
    v_add_f32 v98, 1.0, v98
    v_mfma_f32_16x16x32_bf16 v[76:79], v[48:51], v[156:159], v[76:79]
    v_add_f32 v99, 1.0, v99
    v_mfma_f32_16x16x32_bf16 v[72:75], v[52:55], v[160:163], v[72:75]
    v_add_f32 v100, 1.0, v100
    v_mfma_f32_16x16x32_bf16 v[76:79], v[52:55], v[164:167], v[76:79]
    s_add_u32 s12, s15, 13312
    buffer_load_dwordx4 v[124:127], v206, s[76:79], s12 offen
    v_add_f32 v101, 1.0, v101
    v_mfma_f32_16x16x32_bf16 v[72:75], v[56:59], v[168:171], v[72:75]
    v_add_f32 v102, 1.0, v102
    v_add_f32 v103, 1.0, v103
    v_mfma_f32_16x16x32_bf16 v[76:79], v[56:59], v[172:175], v[76:79]
    v_rcp_f32 v96, v96
    v_mfma_f32_16x16x32_bf16 v[72:75], v[60:63], v[176:179], v[72:75]
    v_rcp_f32 v97, v97
    v_mfma_f32_16x16x32_bf16 v[76:79], v[60:63], v[180:183], v[76:79]
    v_rcp_f32 v98, v98
    v_mfma_f32_16x16x32_bf16 v[72:75], v[64:67], v[184:187], v[72:75]
    v_rcp_f32 v99, v99
    v_mfma_f32_16x16x32_bf16 v[76:79], v[64:67], v[188:191], v[76:79]
    v_rcp_f32 v100, v100
    v_mfma_f32_16x16x32_bf16 v[72:75], v[68:71], v[192:195], v[72:75]
    v_rcp_f32 v101, v101
    v_mfma_f32_16x16x32_bf16 v[76:79], v[68:71], v[196:199], v[76:79]
    v_rcp_f32 v102, v102
    v_rcp_f32 v103, v103
    v_mul_f32 v96, v88, v96
    v_mul_f32 v97, v89, v97
    v_mul_f32 v98, v90, v98
    v_mul_f32 v99, v91, v99
    v_mul_f32 v100, v92, v100
    v_mul_f32 v101, v93, v101
    v_mul_f32 v102, v94, v102
    v_mul_f32 v103, v95, v103
    v_cvt_pk_bf16_f32 v104, v96, v97
    v_cvt_pk_bf16_f32 v105, v98, v99
    v_cvt_pk_bf16_f32 v106, v100, v101
    v_cvt_pk_bf16_f32 v107, v102, v103
    ds_write_b64 v218, v[104:105] offset:128
    ds_write_b64 v218, v[106:107] offset:7296
    v_exp_f32_e64 v96, -v72
    v_exp_f32_e64 v97, -v73
    v_exp_f32_e64 v98, -v74
    v_exp_f32_e64 v99, -v75
    v_exp_f32_e64 v100, -v76
    v_exp_f32_e64 v101, -v77
    v_exp_f32_e64 v102, -v78
    v_exp_f32_e64 v103, -v79
    v_add_f32 v96, 1.0, v96
    v_add_f32 v97, 1.0, v97
    v_add_f32 v98, 1.0, v98
    v_add_f32 v99, 1.0, v99
    v_add_f32 v100, 1.0, v100
    v_add_f32 v101, 1.0, v101
    v_add_f32 v102, 1.0, v102
    v_add_f32 v103, 1.0, v103
    v_rcp_f32 v96, v96
    v_rcp_f32 v97, v97
    v_rcp_f32 v98, v98
    v_rcp_f32 v99, v99
    v_rcp_f32 v100, v100
    v_rcp_f32 v101, v101
    v_rcp_f32 v102, v102
    v_rcp_f32 v103, v103
    v_mul_f32 v96, v72, v96
    v_mul_f32 v97, v73, v97
    v_mul_f32 v98, v74, v98
    v_mul_f32 v99, v75, v99
    v_mul_f32 v100, v76, v100
    v_mul_f32 v101, v77, v101
    v_mul_f32 v102, v78, v102
    v_mul_f32 v103, v79, v103
    v_cvt_pk_bf16_f32 v104, v96, v97
    v_cvt_pk_bf16_f32 v105, v98, v99
    v_cvt_pk_bf16_f32 v106, v100, v101
    v_cvt_pk_bf16_f32 v107, v102, v103
    ds_write_b64 v204, v[104:105] offset:192
    ds_write_b64 v204, v[106:107] offset:7360
    s_waitcnt lgkmcnt(0)
    s_barrier
    s_lshr_b32 s10, s6, 1
    s_add_u32 s11, s10, 0
    s_and_b32 s11, s11, 3
    s_mul_i32 s12, s11, 7168
    v_add_u32 v116, s12, v205
    s_mul_i32 s40, s11, 14336
    s_add_u32 s11, s10, 1
    s_and_b32 s11, s11, 3
    s_mul_i32 s12, s11, 7168
    v_add_u32 v117, s12, v205
    s_mul_i32 s41, s11, 14336
    s_add_u32 s11, s10, 2
    s_and_b32 s11, s11, 3
    s_mul_i32 s12, s11, 7168
    v_add_u32 v118, s12, v205
    s_mul_i32 s42, s11, 14336
    s_add_u32 s11, s10, 3
    s_and_b32 s11, s11, 3
    s_mul_i32 s12, s11, 7168
    v_add_u32 v119, s12, v205
    s_mul_i32 s43, s11, 14336
    ds_read_b128 a[196:199], v116 offset:0
    ds_read_b128 a[200:203], v116 offset:64
    ds_read_b128 a[204:207], v116 offset:128
    ds_read_b128 a[208:211], v116 offset:192
    ds_read_b128 a[212:215], v116 offset:256
    ds_read_b128 a[216:219], v116 offset:320
    ds_read_b128 a[220:223], v116 offset:384
    s_and_b32 s11, s6, 1
    s_mov_b32 s14, 0x00ff00ff
    s_lshl_b32 s12, s11, 3
    s_lshl_b32 s14, s14, s12
    s_mov_b32 s15, s14
    v_and_b32 v122, 15, v0
    v_mul_u32_u24 v123, 896, v122
    v_and_b32 v122, 7, v122
    v_mul_u32_u24 v122, 912, v122
    v_sub_u32 v122, v122, v123
    v_add_u32 v122, 143360, v122
    v_add_u32 v120, v122, v207
    v_add_u32 v121, v122, v208
    v_add_u32 v122, 150656, v206
    v_cndmask_b32 v120, v122, v120, s[14:15]
    v_cndmask_b32 v121, v122, v121, s[14:15]
    v_bfrev_b32 v123, 1
    v_cndmask_b32 v122, v207, v123, s[14:15]
    v_cndmask_b32 v123, v208, v123, s[14:15]
    s_waitcnt lgkmcnt(6)
    v_mfma_f32_16x16x32_bf16 v[72:75], a[24:27], a[196:199], 0
    ds_read_b128 a[224:227], v117 offset:0
    s_waitcnt lgkmcnt(6)
    v_mfma_f32_16x16x32_bf16 v[72:75], a[52:55], a[200:203], v[72:75]
    ds_read_b128 a[228:231], v117 offset:64
    s_waitcnt lgkmcnt(6)
    v_mfma_f32_16x16x32_bf16 v[72:75], a[80:83], a[204:207], v[72:75]
    ds_read_b128 a[232:235], v117 offset:128
    s_waitcnt lgkmcnt(6)
    v_mfma_f32_16x16x32_bf16 v[72:75], a[108:111], a[208:211], v[72:75]
    ds_read_b128 a[236:239], v117 offset:192
    s_waitcnt lgkmcnt(6)
    v_mfma_f32_16x16x32_bf16 v[72:75], a[136:139], a[212:215], v[72:75]
    ds_read_b128 a[240:243], v117 offset:256
    s_waitcnt lgkmcnt(6)
    v_mfma_f32_16x16x32_bf16 v[72:75], a[164:167], a[216:219], v[72:75]
    ds_read_b128 a[244:247], v117 offset:320
    s_waitcnt lgkmcnt(6)
    v_mfma_f32_16x16x32_bf16 v[72:75], a[192:195], a[220:223], v[72:75]
    ds_read_b128 a[248:251], v117 offset:384
    s_waitcnt lgkmcnt(6)
    v_mfma_f32_16x16x32_bf16 v[80:83], a[24:27], a[224:227], 0
    ds_read_b128 a[252:255], v118 offset:0
    s_waitcnt lgkmcnt(6)
    v_mfma_f32_16x16x32_bf16 v[80:83], a[52:55], a[228:231], v[80:83]
    ds_read_b128 v[148:151], v118 offset:64
    s_waitcnt lgkmcnt(6)
    v_mfma_f32_16x16x32_bf16 v[80:83], a[80:83], a[232:235], v[80:83]
    ds_read_b128 v[152:155], v118 offset:128
    s_waitcnt lgkmcnt(6)
    v_mfma_f32_16x16x32_bf16 v[80:83], a[108:111], a[236:239], v[80:83]
    ds_read_b128 v[156:159], v118 offset:192
    s_waitcnt lgkmcnt(6)
    v_mfma_f32_16x16x32_bf16 v[80:83], a[136:139], a[240:243], v[80:83]
    ds_read_b128 v[160:163], v118 offset:256
    v_cvt_pk_bf16_f32 v16, v72, v73
    s_waitcnt lgkmcnt(6)
    v_mfma_f32_16x16x32_bf16 v[80:83], a[164:167], a[244:247], v[80:83]
    ds_read_b128 v[164:167], v118 offset:320
    v_cvt_pk_bf16_f32 v17, v74, v75
    s_waitcnt lgkmcnt(6)
    v_mfma_f32_16x16x32_bf16 v[80:83], a[192:195], a[248:251], v[80:83]
    ds_read_b128 v[168:171], v118 offset:384
    buffer_store_dwordx2 v[16:17], v123, s[76:79], s40 offen nt
    ds_write_b64 v121, v[16:17]
    s_waitcnt lgkmcnt(7)
    v_mfma_f32_16x16x32_bf16 v[72:75], a[24:27], a[252:255], 0
    ds_read_b128 v[172:175], v119 offset:0
    s_waitcnt lgkmcnt(7)
    v_mfma_f32_16x16x32_bf16 v[72:75], a[52:55], v[148:151], v[72:75]
    ds_read_b128 v[176:179], v119 offset:64
    s_waitcnt lgkmcnt(7)
    v_mfma_f32_16x16x32_bf16 v[72:75], a[80:83], v[152:155], v[72:75]
    ds_read_b128 v[180:183], v119 offset:128
    s_waitcnt lgkmcnt(7)
    v_mfma_f32_16x16x32_bf16 v[72:75], a[108:111], v[156:159], v[72:75]
    ds_read_b128 v[184:187], v119 offset:192
    s_waitcnt lgkmcnt(7)
    v_mfma_f32_16x16x32_bf16 v[72:75], a[136:139], v[160:163], v[72:75]
    ds_read_b128 v[188:191], v119 offset:256
    v_cvt_pk_bf16_f32 v20, v80, v81
    s_waitcnt lgkmcnt(7)
    v_mfma_f32_16x16x32_bf16 v[72:75], a[164:167], v[164:167], v[72:75]
    ds_read_b128 v[192:195], v119 offset:320
    v_cvt_pk_bf16_f32 v21, v82, v83
    s_waitcnt lgkmcnt(7)
    v_mfma_f32_16x16x32_bf16 v[72:75], a[192:195], v[168:171], v[72:75]
    ds_read_b128 v[196:199], v119 offset:384
    buffer_store_dwordx2 v[20:21], v208, s[76:79], s41 offen nt
    s_waitcnt lgkmcnt(6)
    v_mfma_f32_16x16x32_bf16 v[80:83], a[24:27], v[172:175], 0
    s_waitcnt lgkmcnt(5)
    v_mfma_f32_16x16x32_bf16 v[80:83], a[52:55], v[176:179], v[80:83]
    s_waitcnt lgkmcnt(4)
    v_mfma_f32_16x16x32_bf16 v[80:83], a[80:83], v[180:183], v[80:83]
    s_waitcnt lgkmcnt(3)
    v_mfma_f32_16x16x32_bf16 v[80:83], a[108:111], v[184:187], v[80:83]
    s_waitcnt lgkmcnt(2)
    v_mfma_f32_16x16x32_bf16 v[80:83], a[136:139], v[188:191], v[80:83]
    v_cvt_pk_bf16_f32 v24, v72, v73
    s_waitcnt lgkmcnt(1)
    v_mfma_f32_16x16x32_bf16 v[80:83], a[164:167], v[192:195], v[80:83]
    v_cvt_pk_bf16_f32 v25, v74, v75
    s_waitcnt lgkmcnt(0)
    v_mfma_f32_16x16x32_bf16 v[80:83], a[192:195], v[196:199], v[80:83]
    buffer_store_dwordx2 v[24:25], v208, s[76:79], s42 offen nt
    v_mfma_f32_16x16x32_bf16 v[72:75], a[0:3], a[196:199], 0
    v_mfma_f32_16x16x32_bf16 v[76:79], a[4:7], a[196:199], 0
    v_mfma_f32_16x16x32_bf16 v[72:75], a[28:31], a[200:203], v[72:75]
    v_mfma_f32_16x16x32_bf16 v[76:79], a[32:35], a[200:203], v[76:79]
    v_mfma_f32_16x16x32_bf16 v[72:75], a[56:59], a[204:207], v[72:75]
    v_mfma_f32_16x16x32_bf16 v[76:79], a[60:63], a[204:207], v[76:79]
    s_nop 0
    v_cvt_pk_bf16_f32 v28, v80, v81
    v_mfma_f32_16x16x32_bf16 v[72:75], a[84:87], a[208:211], v[72:75]
    v_mfma_f32_16x16x32_bf16 v[76:79], a[88:91], a[208:211], v[76:79]
    v_cvt_pk_bf16_f32 v29, v82, v83
    v_mfma_f32_16x16x32_bf16 v[72:75], a[112:115], a[212:215], v[72:75]
    v_mfma_f32_16x16x32_bf16 v[76:79], a[116:119], a[212:215], v[76:79]
    v_mfma_f32_16x16x32_bf16 v[72:75], a[140:143], a[216:219], v[72:75]
    buffer_store_dwordx2 v[28:29], v208, s[76:79], s43 offen nt
    v_mfma_f32_16x16x32_bf16 v[76:79], a[144:147], a[216:219], v[76:79]
    v_mfma_f32_16x16x32_bf16 v[72:75], a[168:171], a[220:223], v[72:75]
    v_mfma_f32_16x16x32_bf16 v[76:79], a[172:175], a[220:223], v[76:79]
    v_mfma_f32_16x16x32_bf16 v[80:83], a[0:3], a[224:227], 0
    v_mfma_f32_16x16x32_bf16 v[84:87], a[4:7], a[224:227], 0
    v_mfma_f32_16x16x32_bf16 v[80:83], a[28:31], a[228:231], v[80:83]
    v_mfma_f32_16x16x32_bf16 v[84:87], a[32:35], a[228:231], v[84:87]
    v_mfma_f32_16x16x32_bf16 v[80:83], a[56:59], a[232:235], v[80:83]
    v_mfma_f32_16x16x32_bf16 v[84:87], a[60:63], a[232:235], v[84:87]
    s_nop 0
    v_cvt_pk_bf16_f32 v16, v72, v73
    v_mfma_f32_16x16x32_bf16 v[80:83], a[84:87], a[236:239], v[80:83]
    v_cvt_pk_bf16_f32 v17, v74, v75
    v_mfma_f32_16x16x32_bf16 v[84:87], a[88:91], a[236:239], v[84:87]
    v_cvt_pk_bf16_f32 v18, v76, v77
    v_mfma_f32_16x16x32_bf16 v[80:83], a[112:115], a[240:243], v[80:83]
    v_cvt_pk_bf16_f32 v19, v78, v79
    v_mfma_f32_16x16x32_bf16 v[84:87], a[116:119], a[240:243], v[84:87]
    v_mfma_f32_16x16x32_bf16 v[80:83], a[140:143], a[244:247], v[80:83]
    buffer_store_dwordx4 v[16:19], v122, s[76:79], s40 offen offset:0 nt
    ds_write_b128 v120, v[16:19] offset:0
    v_mfma_f32_16x16x32_bf16 v[84:87], a[144:147], a[244:247], v[84:87]
    v_mfma_f32_16x16x32_bf16 v[80:83], a[168:171], a[248:251], v[80:83]
    v_mfma_f32_16x16x32_bf16 v[84:87], a[172:175], a[248:251], v[84:87]
    v_mfma_f32_16x16x32_bf16 v[72:75], a[0:3], a[252:255], 0
    v_mfma_f32_16x16x32_bf16 v[76:79], a[4:7], a[252:255], 0
    v_mfma_f32_16x16x32_bf16 v[72:75], a[28:31], v[148:151], v[72:75]
    v_mfma_f32_16x16x32_bf16 v[76:79], a[32:35], v[148:151], v[76:79]
    v_mfma_f32_16x16x32_bf16 v[72:75], a[56:59], v[152:155], v[72:75]
    v_mfma_f32_16x16x32_bf16 v[76:79], a[60:63], v[152:155], v[76:79]
    s_nop 0
    v_cvt_pk_bf16_f32 v20, v80, v81
    v_mfma_f32_16x16x32_bf16 v[72:75], a[84:87], v[156:159], v[72:75]
    v_cvt_pk_bf16_f32 v21, v82, v83
    v_mfma_f32_16x16x32_bf16 v[76:79], a[88:91], v[156:159], v[76:79]
    v_cvt_pk_bf16_f32 v22, v84, v85
    v_mfma_f32_16x16x32_bf16 v[72:75], a[112:115], v[160:163], v[72:75]
    v_cvt_pk_bf16_f32 v23, v86, v87
    v_mfma_f32_16x16x32_bf16 v[76:79], a[116:119], v[160:163], v[76:79]
    v_mfma_f32_16x16x32_bf16 v[72:75], a[140:143], v[164:167], v[72:75]
    buffer_store_dwordx4 v[20:23], v207, s[76:79], s41 offen offset:0 nt
    v_mfma_f32_16x16x32_bf16 v[76:79], a[144:147], v[164:167], v[76:79]
    v_mfma_f32_16x16x32_bf16 v[72:75], a[168:171], v[168:171], v[72:75]
    v_mfma_f32_16x16x32_bf16 v[76:79], a[172:175], v[168:171], v[76:79]
    v_mfma_f32_16x16x32_bf16 v[80:83], a[0:3], v[172:175], 0
    v_mfma_f32_16x16x32_bf16 v[84:87], a[4:7], v[172:175], 0
    v_mfma_f32_16x16x32_bf16 v[80:83], a[28:31], v[176:179], v[80:83]
    v_mfma_f32_16x16x32_bf16 v[84:87], a[32:35], v[176:179], v[84:87]
    v_mfma_f32_16x16x32_bf16 v[80:83], a[56:59], v[180:183], v[80:83]
    v_mfma_f32_16x16x32_bf16 v[84:87], a[60:63], v[180:183], v[84:87]
    s_nop 0
    v_cvt_pk_bf16_f32 v24, v72, v73
    v_mfma_f32_16x16x32_bf16 v[80:83], a[84:87], v[184:187], v[80:83]
    v_cvt_pk_bf16_f32 v25, v74, v75
    v_mfma_f32_16x16x32_bf16 v[84:87], a[88:91], v[184:187], v[84:87]
    v_cvt_pk_bf16_f32 v26, v76, v77
    v_mfma_f32_16x16x32_bf16 v[80:83], a[112:115], v[188:191], v[80:83]
    v_cvt_pk_bf16_f32 v27, v78, v79
    v_mfma_f32_16x16x32_bf16 v[84:87], a[116:119], v[188:191], v[84:87]
    v_mfma_f32_16x16x32_bf16 v[80:83], a[140:143], v[192:195], v[80:83]
    buffer_store_dwordx4 v[24:27], v207, s[76:79], s42 offen offset:0 nt
    v_mfma_f32_16x16x32_bf16 v[84:87], a[144:147], v[192:195], v[84:87]
    v_mfma_f32_16x16x32_bf16 v[80:83], a[168:171], v[196:199], v[80:83]
    v_mfma_f32_16x16x32_bf16 v[84:87], a[172:175], v[196:199], v[84:87]
    v_mfma_f32_16x16x32_bf16 v[72:75], a[8:11], a[196:199], 0
    v_mfma_f32_16x16x32_bf16 v[76:79], a[12:15], a[196:199], 0
    v_mfma_f32_16x16x32_bf16 v[72:75], a[36:39], a[200:203], v[72:75]
    v_mfma_f32_16x16x32_bf16 v[76:79], a[40:43], a[200:203], v[76:79]
    v_mfma_f32_16x16x32_bf16 v[72:75], a[64:67], a[204:207], v[72:75]
    v_mfma_f32_16x16x32_bf16 v[76:79], a[68:71], a[204:207], v[76:79]
    s_nop 0
    v_cvt_pk_bf16_f32 v28, v80, v81
    v_mfma_f32_16x16x32_bf16 v[72:75], a[92:95], a[208:211], v[72:75]
    v_cvt_pk_bf16_f32 v29, v82, v83
    v_mfma_f32_16x16x32_bf16 v[76:79], a[96:99], a[208:211], v[76:79]
    v_cvt_pk_bf16_f32 v30, v84, v85
    v_mfma_f32_16x16x32_bf16 v[72:75], a[120:123], a[212:215], v[72:75]
    v_cvt_pk_bf16_f32 v31, v86, v87
    v_mfma_f32_16x16x32_bf16 v[76:79], a[124:127], a[212:215], v[76:79]
    v_mfma_f32_16x16x32_bf16 v[72:75], a[148:151], a[216:219], v[72:75]
    buffer_store_dwordx4 v[28:31], v207, s[76:79], s43 offen offset:0 nt
    v_mfma_f32_16x16x32_bf16 v[76:79], a[152:155], a[216:219], v[76:79]
    v_mfma_f32_16x16x32_bf16 v[72:75], a[176:179], a[220:223], v[72:75]
    v_mfma_f32_16x16x32_bf16 v[76:79], a[180:183], a[220:223], v[76:79]
    v_mfma_f32_16x16x32_bf16 v[80:83], a[8:11], a[224:227], 0
    v_mfma_f32_16x16x32_bf16 v[84:87], a[12:15], a[224:227], 0
    v_mfma_f32_16x16x32_bf16 v[80:83], a[36:39], a[228:231], v[80:83]
    v_mfma_f32_16x16x32_bf16 v[84:87], a[40:43], a[228:231], v[84:87]
    v_mfma_f32_16x16x32_bf16 v[80:83], a[64:67], a[232:235], v[80:83]
    v_mfma_f32_16x16x32_bf16 v[84:87], a[68:71], a[232:235], v[84:87]
    s_nop 0
    v_cvt_pk_bf16_f32 v16, v72, v73
    v_mfma_f32_16x16x32_bf16 v[80:83], a[92:95], a[236:239], v[80:83]
    v_cvt_pk_bf16_f32 v17, v74, v75
    v_mfma_f32_16x16x32_bf16 v[84:87], a[96:99], a[236:239], v[84:87]
    v_cvt_pk_bf16_f32 v18, v76, v77
    v_mfma_f32_16x16x32_bf16 v[80:83], a[120:123], a[240:243], v[80:83]
    v_cvt_pk_bf16_f32 v19, v78, v79
    v_mfma_f32_16x16x32_bf16 v[84:87], a[124:127], a[240:243], v[84:87]
    v_mfma_f32_16x16x32_bf16 v[80:83], a[148:151], a[244:247], v[80:83]
    buffer_store_dwordx4 v[16:19], v122, s[76:79], s40 offen offset:256 nt
    ds_write_b128 v120, v[16:19] offset:256
    v_mfma_f32_16x16x32_bf16 v[84:87], a[152:155], a[244:247], v[84:87]
    v_mfma_f32_16x16x32_bf16 v[80:83], a[176:179], a[248:251], v[80:83]
    v_mfma_f32_16x16x32_bf16 v[84:87], a[180:183], a[248:251], v[84:87]
    v_mfma_f32_16x16x32_bf16 v[72:75], a[8:11], a[252:255], 0
    v_mfma_f32_16x16x32_bf16 v[76:79], a[12:15], a[252:255], 0
    v_mfma_f32_16x16x32_bf16 v[72:75], a[36:39], v[148:151], v[72:75]
    v_mfma_f32_16x16x32_bf16 v[76:79], a[40:43], v[148:151], v[76:79]
    v_mfma_f32_16x16x32_bf16 v[72:75], a[64:67], v[152:155], v[72:75]
    v_mfma_f32_16x16x32_bf16 v[76:79], a[68:71], v[152:155], v[76:79]
    s_nop 0
    v_cvt_pk_bf16_f32 v20, v80, v81
    v_mfma_f32_16x16x32_bf16 v[72:75], a[92:95], v[156:159], v[72:75]
    v_cvt_pk_bf16_f32 v21, v82, v83
    v_mfma_f32_16x16x32_bf16 v[76:79], a[96:99], v[156:159], v[76:79]
    v_cvt_pk_bf16_f32 v22, v84, v85
    v_mfma_f32_16x16x32_bf16 v[72:75], a[120:123], v[160:163], v[72:75]
    v_cvt_pk_bf16_f32 v23, v86, v87
    v_mfma_f32_16x16x32_bf16 v[76:79], a[124:127], v[160:163], v[76:79]
    v_mfma_f32_16x16x32_bf16 v[72:75], a[148:151], v[164:167], v[72:75]
    buffer_store_dwordx4 v[20:23], v207, s[76:79], s41 offen offset:256 nt
    v_mfma_f32_16x16x32_bf16 v[76:79], a[152:155], v[164:167], v[76:79]
    v_mfma_f32_16x16x32_bf16 v[72:75], a[176:179], v[168:171], v[72:75]
    v_mfma_f32_16x16x32_bf16 v[76:79], a[180:183], v[168:171], v[76:79]
    v_mfma_f32_16x16x32_bf16 v[80:83], a[8:11], v[172:175], 0
    v_mfma_f32_16x16x32_bf16 v[84:87], a[12:15], v[172:175], 0
    v_mfma_f32_16x16x32_bf16 v[80:83], a[36:39], v[176:179], v[80:83]
    v_mfma_f32_16x16x32_bf16 v[84:87], a[40:43], v[176:179], v[84:87]
    v_mfma_f32_16x16x32_bf16 v[80:83], a[64:67], v[180:183], v[80:83]
    v_mfma_f32_16x16x32_bf16 v[84:87], a[68:71], v[180:183], v[84:87]
    s_nop 0
    v_cvt_pk_bf16_f32 v24, v72, v73
    v_mfma_f32_16x16x32_bf16 v[80:83], a[92:95], v[184:187], v[80:83]
    v_cvt_pk_bf16_f32 v25, v74, v75
    v_mfma_f32_16x16x32_bf16 v[84:87], a[96:99], v[184:187], v[84:87]
    v_cvt_pk_bf16_f32 v26, v76, v77
    v_mfma_f32_16x16x32_bf16 v[80:83], a[120:123], v[188:191], v[80:83]
    v_cvt_pk_bf16_f32 v27, v78, v79
    v_mfma_f32_16x16x32_bf16 v[84:87], a[124:127], v[188:191], v[84:87]
    v_mfma_f32_16x16x32_bf16 v[80:83], a[148:151], v[192:195], v[80:83]
    buffer_store_dwordx4 v[24:27], v207, s[76:79], s42 offen offset:256 nt
    v_mfma_f32_16x16x32_bf16 v[84:87], a[152:155], v[192:195], v[84:87]
    v_mfma_f32_16x16x32_bf16 v[80:83], a[176:179], v[196:199], v[80:83]
    v_mfma_f32_16x16x32_bf16 v[84:87], a[180:183], v[196:199], v[84:87]
    v_mfma_f32_16x16x32_bf16 v[72:75], a[16:19], a[196:199], 0
    v_mfma_f32_16x16x32_bf16 v[76:79], a[20:23], a[196:199], 0
    v_mfma_f32_16x16x32_bf16 v[72:75], a[44:47], a[200:203], v[72:75]
    v_mfma_f32_16x16x32_bf16 v[76:79], a[48:51], a[200:203], v[76:79]
    v_mfma_f32_16x16x32_bf16 v[72:75], a[72:75], a[204:207], v[72:75]
    v_mfma_f32_16x16x32_bf16 v[76:79], a[76:79], a[204:207], v[76:79]
    s_nop 0
    v_cvt_pk_bf16_f32 v28, v80, v81
    v_mfma_f32_16x16x32_bf16 v[72:75], a[100:103], a[208:211], v[72:75]
    v_cvt_pk_bf16_f32 v29, v82, v83
    v_mfma_f32_16x16x32_bf16 v[76:79], a[104:107], a[208:211], v[76:79]
    v_cvt_pk_bf16_f32 v30, v84, v85
    v_mfma_f32_16x16x32_bf16 v[72:75], a[128:131], a[212:215], v[72:75]
    v_cvt_pk_bf16_f32 v31, v86, v87
    v_mfma_f32_16x16x32_bf16 v[76:79], a[132:135], a[212:215], v[76:79]
    v_mfma_f32_16x16x32_bf16 v[72:75], a[156:159], a[216:219], v[72:75]
    buffer_store_dwordx4 v[28:31], v207, s[76:79], s43 offen offset:256 nt
    v_mfma_f32_16x16x32_bf16 v[76:79], a[160:163], a[216:219], v[76:79]
    v_mfma_f32_16x16x32_bf16 v[72:75], a[184:187], a[220:223], v[72:75]
    v_mfma_f32_16x16x32_bf16 v[76:79], a[188:191], a[220:223], v[76:79]
    v_mfma_f32_16x16x32_bf16 v[80:83], a[16:19], a[224:227], 0
    v_mfma_f32_16x16x32_bf16 v[84:87], a[20:23], a[224:227], 0
    v_mfma_f32_16x16x32_bf16 v[80:83], a[44:47], a[228:231], v[80:83]
    v_mfma_f32_16x16x32_bf16 v[84:87], a[48:51], a[228:231], v[84:87]
    v_mfma_f32_16x16x32_bf16 v[80:83], a[72:75], a[232:235], v[80:83]
    v_mfma_f32_16x16x32_bf16 v[84:87], a[76:79], a[232:235], v[84:87]
    s_nop 0
    v_cvt_pk_bf16_f32 v16, v72, v73
    v_mfma_f32_16x16x32_bf16 v[80:83], a[100:103], a[236:239], v[80:83]
    v_cvt_pk_bf16_f32 v17, v74, v75
    v_mfma_f32_16x16x32_bf16 v[84:87], a[104:107], a[236:239], v[84:87]
    v_cvt_pk_bf16_f32 v18, v76, v77
    v_mfma_f32_16x16x32_bf16 v[80:83], a[128:131], a[240:243], v[80:83]
    v_cvt_pk_bf16_f32 v19, v78, v79
    v_mfma_f32_16x16x32_bf16 v[84:87], a[132:135], a[240:243], v[84:87]
    v_mfma_f32_16x16x32_bf16 v[80:83], a[156:159], a[244:247], v[80:83]
    buffer_store_dwordx4 v[16:19], v122, s[76:79], s40 offen offset:512 nt
    ds_write_b128 v120, v[16:19] offset:512
    v_mfma_f32_16x16x32_bf16 v[84:87], a[160:163], a[244:247], v[84:87]
    v_mfma_f32_16x16x32_bf16 v[80:83], a[184:187], a[248:251], v[80:83]
    v_mfma_f32_16x16x32_bf16 v[84:87], a[188:191], a[248:251], v[84:87]
    v_mfma_f32_16x16x32_bf16 v[72:75], a[16:19], a[252:255], 0
    v_mfma_f32_16x16x32_bf16 v[76:79], a[20:23], a[252:255], 0
    v_mfma_f32_16x16x32_bf16 v[72:75], a[44:47], v[148:151], v[72:75]
    v_mfma_f32_16x16x32_bf16 v[76:79], a[48:51], v[148:151], v[76:79]
    v_mfma_f32_16x16x32_bf16 v[72:75], a[72:75], v[152:155], v[72:75]
    v_mfma_f32_16x16x32_bf16 v[76:79], a[76:79], v[152:155], v[76:79]
    s_nop 0
    v_cvt_pk_bf16_f32 v20, v80, v81
    v_mfma_f32_16x16x32_bf16 v[72:75], a[100:103], v[156:159], v[72:75]
    v_cvt_pk_bf16_f32 v21, v82, v83
    v_mfma_f32_16x16x32_bf16 v[76:79], a[104:107], v[156:159], v[76:79]
    v_cvt_pk_bf16_f32 v22, v84, v85
    v_mfma_f32_16x16x32_bf16 v[72:75], a[128:131], v[160:163], v[72:75]
    v_cvt_pk_bf16_f32 v23, v86, v87
    v_mfma_f32_16x16x32_bf16 v[76:79], a[132:135], v[160:163], v[76:79]
    v_mfma_f32_16x16x32_bf16 v[72:75], a[156:159], v[164:167], v[72:75]
    buffer_store_dwordx4 v[20:23], v207, s[76:79], s41 offen offset:512 nt
    v_mfma_f32_16x16x32_bf16 v[76:79], a[160:163], v[164:167], v[76:79]
    v_mfma_f32_16x16x32_bf16 v[72:75], a[184:187], v[168:171], v[72:75]
    v_mfma_f32_16x16x32_bf16 v[76:79], a[188:191], v[168:171], v[76:79]
    v_mfma_f32_16x16x32_bf16 v[80:83], a[16:19], v[172:175], 0
    v_mfma_f32_16x16x32_bf16 v[84:87], a[20:23], v[172:175], 0
    v_mfma_f32_16x16x32_bf16 v[80:83], a[44:47], v[176:179], v[80:83]
    v_mfma_f32_16x16x32_bf16 v[84:87], a[48:51], v[176:179], v[84:87]
    v_mfma_f32_16x16x32_bf16 v[80:83], a[72:75], v[180:183], v[80:83]
    v_mfma_f32_16x16x32_bf16 v[84:87], a[76:79], v[180:183], v[84:87]
    s_nop 0
    v_cvt_pk_bf16_f32 v24, v72, v73
    v_mfma_f32_16x16x32_bf16 v[80:83], a[100:103], v[184:187], v[80:83]
    v_cvt_pk_bf16_f32 v25, v74, v75
    v_mfma_f32_16x16x32_bf16 v[84:87], a[104:107], v[184:187], v[84:87]
    v_cvt_pk_bf16_f32 v26, v76, v77
    v_mfma_f32_16x16x32_bf16 v[80:83], a[128:131], v[188:191], v[80:83]
    v_cvt_pk_bf16_f32 v27, v78, v79
    v_mfma_f32_16x16x32_bf16 v[84:87], a[132:135], v[188:191], v[84:87]
    v_mfma_f32_16x16x32_bf16 v[80:83], a[156:159], v[192:195], v[80:83]
    buffer_store_dwordx4 v[24:27], v207, s[76:79], s42 offen offset:512 nt
    v_mfma_f32_16x16x32_bf16 v[84:87], a[160:163], v[192:195], v[84:87]
    v_mfma_f32_16x16x32_bf16 v[80:83], a[184:187], v[196:199], v[80:83]
    v_mfma_f32_16x16x32_bf16 v[84:87], a[188:191], v[196:199], v[84:87]
    s_nop 6
    v_cvt_pk_bf16_f32 v28, v80, v81
    v_cvt_pk_bf16_f32 v29, v82, v83
    v_cvt_pk_bf16_f32 v30, v84, v85
    v_cvt_pk_bf16_f32 v31, v86, v87
    buffer_store_dwordx4 v[28:31], v207, s[76:79], s43 offen offset:512 nt
    v_and_b32 v10, 7, v0
    s_lshl_b32 s9, s5, 7
    s_lshl_b32 s10, s87, 13
    s_add_u32 s9, s9, s10
    s_add_u32 s9, s9, 69632
    v_lshl_add_u32 v10, v10, 3, s9
    s_lshl_b32 s10, s6, 3
    s_add_u32 s9, s9, s10
    v_mov_b32 v9, s9
    v_mov_b32 v250, s84
    v_mov_b32 v251, s85
    v_and_b32 v1, 31, v0
    v_lshrrev_b32 v2, 5, v0
    s_mul_i32 s9, s6, 7168
    v_mul_u32_u24 v3, 896, v2
    v_lshl_add_u32 v3, v1, 4, v3
    v_mul_u32_u24 v11, 912, v2
    v_lshl_add_u32 v11, v1, 4, v11
    v_add_u32 v11, 143360, v11
    s_add_u32 s40, s6, 1
    s_and_b32 s40, s40, 7
    s_mul_i32 s40, s40, 57344
    s_add_u32 s41, s6, 2
    s_and_b32 s41, s41, 7
    s_mul_i32 s41, s41, 57344
    s_add_u32 s42, s6, 3
    s_and_b32 s42, s42, 7
    s_mul_i32 s42, s42, 57344
    s_add_u32 s43, s6, 4
    s_and_b32 s43, s43, 7
    s_mul_i32 s43, s43, 57344
    s_add_u32 s44, s6, 5
    s_and_b32 s44, s44, 7
    s_mul_i32 s44, s44, 57344
    s_add_u32 s45, s6, 6
    s_and_b32 s45, s45, 7
    s_mul_i32 s45, s45, 57344
    s_add_u32 s46, s6, 7
    s_and_b32 s46, s46, 7
    s_mul_i32 s46, s46, 57344
    v_add_u32 v3, s9, v3
    v_cndmask_b32 v12, -1, v3, s[88:89]
    v_add_u32 v3, 448, v3
    v_cndmask_b32 v13, -1, v3, s[88:89]
    s_waitcnt lgkmcnt(0)
    s_waitcnt vmcnt(0)
    s_barrier
    s_cmp_eq_u32 s3, 0
    s_cbranch_scc0 css_29
    s_mov_b64 exec, 1
    s_cmp_eq_u32 s86, 1
    s_cbranch_scc0 csl_30
    buffer_store_dwordx2 v[250:251], v9, s[64:67], 0 offen
csg_31:
    s_mov_b64 exec, 0xff
    s_mov_b32 s90, 0
csp_32:
    buffer_load_dwordx2 v[2:3], v10, s[64:67], 0 offen sc1
    s_waitcnt vmcnt(0)
    v_cmp_eq_u64 vcc, s[84:85], v[2:3]
    s_add_u32 s90, s90, 1
    s_nop 3
    s_cmp_eq_u64 vcc, exec
    s_cbranch_scc1 csd_33
    s_cmp_lt_u32 s90, 0x100000
    s_cbranch_scc1 csp_32
csd_33:
    s_mov_b64 exec, -1
    s_cmp_eq_u32 s86, 1
    s_cbranch_scc1 css_29
    buffer_inv sc1
    s_waitcnt vmcnt(0)
css_29:
    s_barrier
    buffer_load_dwordx4 v[96:99], v12, s[80:83], s40 offen sc1
    buffer_load_dwordx4 v[100:103], v13, s[80:83], s40 offen sc1
    buffer_load_dwordx4 v[104:107], v12, s[80:83], s41 offen sc1
    buffer_load_dwordx4 v[108:111], v13, s[80:83], s41 offen sc1
    buffer_load_dwordx4 v[112:115], v12, s[80:83], s42 offen sc1
    buffer_load_dwordx4 v[116:119], v13, s[80:83], s42 offen sc1
    buffer_load_dwordx4 v[120:123], v12, s[80:83], s43 offen sc1
    buffer_load_dwordx4 v[124:127], v13, s[80:83], s43 offen sc1
    buffer_load_dwordx4 v[128:131], v12, s[80:83], s44 offen sc1
    buffer_load_dwordx4 v[132:135], v13, s[80:83], s44 offen sc1
    buffer_load_dwordx4 v[136:139], v12, s[80:83], s45 offen sc1
    buffer_load_dwordx4 v[140:143], v13, s[80:83], s45 offen sc1
    buffer_load_dwordx4 v[144:147], v12, s[80:83], s46 offen sc1
    buffer_load_dwordx4 v[148:151], v13, s[80:83], s46 offen sc1
    ds_read_b128 v[152:155], v11
    ds_read_b128 v[156:159], v11 offset:448
    s_cmp_eq_u32 s87, 0
    s_cbranch_scc0 pf2_35
    s_add_u32 m0, s100, 57344
    s_add_u32 s12, s100, 0
    buffer_load_dwordx4 v206, s[68:71], s12 offen offset:0 sc1 lds
    buffer_load_dwordx4 v206, s[68:71], s12 offen offset:1024 sc1 lds
    buffer_load_dwordx4 v206, s[68:71], s12 offen offset:2048 sc1 lds
    buffer_load_dwordx4 v206, s[68:71], s12 offen offset:3072 sc1 lds
    s_add_u32 m0, s100, 61440
    s_add_u32 s12, s100, 4096
    buffer_load_dwordx4 v206, s[68:71], s12 offen offset:0 sc1 lds
    buffer_load_dwordx4 v206, s[68:71], s12 offen offset:1024 sc1 lds
    buffer_load_dwordx4 v206, s[68:71], s12 offen offset:2048 sc1 lds
pf2_35:
    v_mov_b32 v7, 0xffff0000
    v_mov_b32 v14, 0x00003f80
    v_mov_b32 v15, 0x3f800000
    v_lshlrev_b32 v16, 16, v224
    v_and_b32 v17, v7, v224
    v_lshlrev_b32 v18, 16, v225
    v_and_b32 v19, v7, v225
    v_lshlrev_b32 v20, 16, v226
    v_and_b32 v21, v7, v226
    v_lshlrev_b32 v22, 16, v227
    v_and_b32 v23, v7, v227
    v_lshlrev_b32 v24, 16, v228
    v_and_b32 v25, v7, v228
    v_lshlrev_b32 v26, 16, v229
    v_and_b32 v27, v7, v229
    v_lshlrev_b32 v28, 16, v230
    v_and_b32 v29, v7, v230
    v_lshlrev_b32 v30, 16, v231
    v_and_b32 v31, v7, v231
    v_mov_b32 v32, 0
    v_mov_b32 v33, 0
    v_mov_b32 v34, 0
    v_mov_b32 v35, 0
    v_mov_b32 v36, 0
    v_mov_b32 v37, 0
    v_mov_b32 v38, 0
    v_mov_b32 v39, 0
    v_mov_b32 v40, 0
    v_mov_b32 v41, 0
    v_mov_b32 v42, 0
    v_mov_b32 v43, 0
    v_mov_b32 v44, 0
    v_mov_b32 v45, 0
    v_mov_b32 v46, 0
    v_mov_b32 v47, 0
    v_mov_b32 v72, 0x3f317218
    v_mov_b32 v73, 0x3f317218
    s_waitcnt lgkmcnt(0)
    v_dot2c_f32_bf16 v32, v152, v14
    v_dot2c_f32_bf16 v33, v152, v15
    v_dot2c_f32_bf16 v34, v153, v14
    v_dot2c_f32_bf16 v35, v153, v15
    v_dot2c_f32_bf16 v36, v154, v14
    v_dot2c_f32_bf16 v37, v154, v15
    v_dot2c_f32_bf16 v38, v155, v14
    v_dot2c_f32_bf16 v39, v155, v15
    v_dot2c_f32_bf16 v40, v156, v14
    v_dot2c_f32_bf16 v41, v156, v15
    v_dot2c_f32_bf16 v42, v157, v14
    v_dot2c_f32_bf16 v43, v157, v15
    v_dot2c_f32_bf16 v44, v158, v14
    v_dot2c_f32_bf16 v45, v158, v15
    v_dot2c_f32_bf16 v46, v159, v14
    v_dot2c_f32_bf16 v47, v159, v15
    s_waitcnt vmcnt(12)
    v_dot2c_f32_bf16 v32, v96, v14
    v_dot2c_f32_bf16 v33, v96, v15
    v_dot2c_f32_bf16 v34, v97, v14
    v_dot2c_f32_bf16 v35, v97, v15
    v_dot2c_f32_bf16 v36, v98, v14
    v_dot2c_f32_bf16 v37, v98, v15
    v_dot2c_f32_bf16 v38, v99, v14
    v_dot2c_f32_bf16 v39, v99, v15
    v_dot2c_f32_bf16 v40, v100, v14
    v_dot2c_f32_bf16 v41, v100, v15
    v_dot2c_f32_bf16 v42, v101, v14
    v_dot2c_f32_bf16 v43, v101, v15
    v_dot2c_f32_bf16 v44, v102, v14
    v_dot2c_f32_bf16 v45, v102, v15
    v_dot2c_f32_bf16 v46, v103, v14
    v_dot2c_f32_bf16 v47, v103, v15
    s_waitcnt vmcnt(10)
    v_dot2c_f32_bf16 v32, v104, v14
    v_dot2c_f32_bf16 v33, v104, v15
    v_dot2c_f32_bf16 v34, v105, v14
    v_dot2c_f32_bf16 v35, v105, v15
    v_dot2c_f32_bf16 v36, v106, v14
    v_dot2c_f32_bf16 v37, v106, v15
    v_dot2c_f32_bf16 v38, v107, v14
    v_dot2c_f32_bf16 v39, v107, v15
    v_dot2c_f32_bf16 v40, v108, v14
    v_dot2c_f32_bf16 v41, v108, v15
    v_dot2c_f32_bf16 v42, v109, v14
    v_dot2c_f32_bf16 v43, v109, v15
    v_dot2c_f32_bf16 v44, v110, v14
    v_dot2c_f32_bf16 v45, v110, v15
    v_dot2c_f32_bf16 v46, v111, v14
    v_dot2c_f32_bf16 v47, v111, v15
    s_waitcnt vmcnt(8)
    v_dot2c_f32_bf16 v32, v112, v14
    v_dot2c_f32_bf16 v33, v112, v15
    v_dot2c_f32_bf16 v34, v113, v14
    v_dot2c_f32_bf16 v35, v113, v15
    v_dot2c_f32_bf16 v36, v114, v14
    v_dot2c_f32_bf16 v37, v114, v15
    v_dot2c_f32_bf16 v38, v115, v14
    v_dot2c_f32_bf16 v39, v115, v15
    v_dot2c_f32_bf16 v40, v116, v14
    v_dot2c_f32_bf16 v41, v116, v15
    v_dot2c_f32_bf16 v42, v117, v14
    v_dot2c_f32_bf16 v43, v117, v15
    v_dot2c_f32_bf16 v44, v118, v14
    v_dot2c_f32_bf16 v45, v118, v15
    v_dot2c_f32_bf16 v46, v119, v14
    v_dot2c_f32_bf16 v47, v119, v15
    s_waitcnt vmcnt(6)
    v_dot2c_f32_bf16 v32, v120, v14
    v_dot2c_f32_bf16 v33, v120, v15
    v_dot2c_f32_bf16 v34, v121, v14
    v_dot2c_f32_bf16 v35, v121, v15
    v_dot2c_f32_bf16 v36, v122, v14
    v_dot2c_f32_bf16 v37, v122, v15
    v_dot2c_f32_bf16 v38, v123, v14
    v_dot2c_f32_bf16 v39, v123, v15
    v_dot2c_f32_bf16 v40, v124, v14
    v_dot2c_f32_bf16 v41, v124, v15
    v_dot2c_f32_bf16 v42, v125, v14
    v_dot2c_f32_bf16 v43, v125, v15
    v_dot2c_f32_bf16 v44, v126, v14
    v_dot2c_f32_bf16 v45, v126, v15
    v_dot2c_f32_bf16 v46, v127, v14
    v_dot2c_f32_bf16 v47, v127, v15
    s_waitcnt vmcnt(4)
    v_dot2c_f32_bf16 v32, v128, v14
    v_dot2c_f32_bf16 v33, v128, v15
    v_dot2c_f32_bf16 v34, v129, v14
    v_dot2c_f32_bf16 v35, v129, v15
    v_dot2c_f32_bf16 v36, v130, v14
    v_dot2c_f32_bf16 v37, v130, v15
    v_dot2c_f32_bf16 v38, v131, v14
    v_dot2c_f32_bf16 v39, v131, v15
    v_dot2c_f32_bf16 v40, v132, v14
    v_dot2c_f32_bf16 v41, v132, v15
    v_dot2c_f32_bf16 v42, v133, v14
    v_dot2c_f32_bf16 v43, v133, v15
    v_dot2c_f32_bf16 v44, v134, v14
    v_dot2c_f32_bf16 v45, v134, v15
    v_dot2c_f32_bf16 v46, v135, v14
    v_dot2c_f32_bf16 v47, v135, v15
    s_waitcnt vmcnt(2)
    v_dot2c_f32_bf16 v32, v136, v14
    v_dot2c_f32_bf16 v33, v136, v15
    v_dot2c_f32_bf16 v34, v137, v14
    v_dot2c_f32_bf16 v35, v137, v15
    v_dot2c_f32_bf16 v36, v138, v14
    v_dot2c_f32_bf16 v37, v138, v15
    v_dot2c_f32_bf16 v38, v139, v14
    v_dot2c_f32_bf16 v39, v139, v15
    v_dot2c_f32_bf16 v40, v140, v14
    v_dot2c_f32_bf16 v41, v140, v15
    v_dot2c_f32_bf16 v42, v141, v14
    v_dot2c_f32_bf16 v43, v141, v15
    v_dot2c_f32_bf16 v44, v142, v14
    v_dot2c_f32_bf16 v45, v142, v15
    v_dot2c_f32_bf16 v46, v143, v14
    v_dot2c_f32_bf16 v47, v143, v15
    s_waitcnt vmcnt(0)
    v_dot2c_f32_bf16 v32, v144, v14
    v_dot2c_f32_bf16 v33, v144, v15
    v_dot2c_f32_bf16 v34, v145, v14
    v_dot2c_f32_bf16 v35, v145, v15
    v_dot2c_f32_bf16 v36, v146, v14
    v_dot2c_f32_bf16 v37, v146, v15
    v_dot2c_f32_bf16 v38, v147, v14
    v_dot2c_f32_bf16 v39, v147, v15
    v_dot2c_f32_bf16 v40, v148, v14
    v_dot2c_f32_bf16 v41, v148, v15
    v_dot2c_f32_bf16 v42, v149, v14
    v_dot2c_f32_bf16 v43, v149, v15
    v_dot2c_f32_bf16 v44, v150, v14
    v_dot2c_f32_bf16 v45, v150, v15
    v_dot2c_f32_bf16 v46, v151, v14
    v_dot2c_f32_bf16 v47, v151, v15
    v_pk_fma_f32 v[16:17], v[32:33], v[72:73], v[16:17]
    v_pk_fma_f32 v[18:19], v[34:35], v[72:73], v[18:19]
    v_pk_fma_f32 v[20:21], v[36:37], v[72:73], v[20:21]
    v_pk_fma_f32 v[22:23], v[38:39], v[72:73], v[22:23]
    v_pk_fma_f32 v[24:25], v[40:41], v[72:73], v[24:25]
    v_pk_fma_f32 v[26:27], v[42:43], v[72:73], v[26:27]
    v_pk_fma_f32 v[28:29], v[44:45], v[72:73], v[28:29]
    v_pk_fma_f32 v[30:31], v[46:47], v[72:73], v[30:31]
    s_cmp_eq_u32 s87, 1
    s_cbranch_scc1 K_final
    s_mov_b32 s87, 1
    s_branch K_layer
K_final:
    v_cvt_pk_bf16_f32 v224, v16, v17
    v_cvt_pk_bf16_f32 v225, v18, v19
    v_cvt_pk_bf16_f32 v226, v20, v21
    v_cvt_pk_bf16_f32 v227, v22, v23
    v_cvt_pk_bf16_f32 v228, v24, v25
    v_cvt_pk_bf16_f32 v229, v26, v27
    v_cvt_pk_bf16_f32 v230, v28, v29
    v_cvt_pk_bf16_f32 v231, v30, v31
    s_mov_b32 s40, s34
    s_mov_b32 s41, s35
    s_mov_b32 s42, 0x1c0000
    s_mov_b32 s43, 0x20000
    buffer_store_dwordx4 v[224:227], v248, s[40:43], 0 offen nt
    buffer_store_dwordx4 v[228:231], v249, s[40:43], 0 offen nt
    s_endpgm
csl_24:
    buffer_wbl2 sc1
    s_waitcnt vmcnt(0)
    buffer_store_dwordx2 v[250:251], v9, s[64:67], 0 offen sc1
    s_branch csg_25
csl_30:
    buffer_wbl2 sc1
    s_waitcnt vmcnt(0)
    buffer_store_dwordx2 v[250:251], v9, s[64:67], 0 offen sc1
    s_branch csg_31
K_end:
    s_endpgm
.section .rodata,"a"
.p2align 6
.amdhsa_kernel interleave_layers__ssm_conv_h3__dense_activation_silu__prompt_kernel
  .amdhsa_next_free_vgpr 512
  .amdhsa_next_free_sgpr 102
  .amdhsa_accum_offset 256
  .amdhsa_group_segment_fixed_size 0
  .amdhsa_kernarg_size 96
  .amdhsa_user_sgpr_count 2
  .amdhsa_user_sgpr_kernarg_segment_ptr 1
  .amdhsa_system_sgpr_workgroup_id_x 1
  .amdhsa_float_denorm_mode_32 3
.end_amdhsa_kernel
```
